```python
import torch

def _softmax(x, axis=-1):
    return torch.softmax(x, dim=axis)
def _gelu(x):
    return torch.nn.functional.gelu(x, approximate="tanh")
def _silu(x):
    return torch.nn.functional.silu(x)
def _sigmoid(x):
    return torch.sigmoid(x)
def _layernorm(x, axis=-1, eps=1e-5):
    m = x.mean(dim=axis, keepdim=True)
    v = x.var(dim=axis, keepdim=True, unbiased=False)
    return (x - m) / torch.sqrt(v + eps)
def _scatter_add(tgt, idx, src, axis=0):
    return tgt.clone().index_add_(axis, idx, src)
def _segment_sum(src, seg, n):
    out = torch.zeros((n,) + src.shape[1:], dtype=src.dtype)
    return out.index_add_(0, seg, src)
def _pad(x, pw):
    flat = tuple(v for pair in reversed(pw) for v in pair)
    return torch.nn.functional.pad(x, flat)

kernel_name = 'sequential_preLN__linear_kernel_hedgehog__glu_gated_bilinear__prompt'

def setup_inputs():

    _w = (lambda a: (lambda t: t.to(torch.bfloat16) if t.is_floating_point() else t)(torch.as_tensor(a)))
    def _A_setup():
        B, S, D, H = 1, 2048, 512, 32
        Dh = D // H
        return {
            "x": _w((lambda *s: torch.randn(*s, dtype=torch.bfloat16) * 0.05)(B, S, D)),
            "wqkv": _w((lambda *s: torch.randn(*s, dtype=torch.bfloat16) * 0.2)(D, 3 * D)),
            "w_phi": _w((lambda *s: torch.randn(*s, dtype=torch.bfloat16) * 0.2)(H, Dh, Dh) * (Dh ** -0.5)),
            "wo": _w((lambda *s: torch.randn(*s, dtype=torch.bfloat16) * 0.05)(D, D)),
        }
    _A_in = _A_setup()

    def _B_setup():
        B, S, D, F = 1, 2048, 512, 1792
        return {
            "x": _w((lambda *s: torch.randn(*s, dtype=torch.bfloat16) * 0.05)(B, S, D)),
            "w_gate": _w((lambda *s: torch.randn(*s, dtype=torch.bfloat16) * 0.4)(D, F) * (D ** -0.5)),
            "w_up": _w((lambda *s: torch.randn(*s, dtype=torch.bfloat16) * 0.4)(D, F) * (D ** -0.5)),
            "w_down": _w((lambda *s: torch.randn(*s, dtype=torch.bfloat16) * 0.4)(F, D) * (F ** -0.5)),
        }
    _B_in = _B_setup()

    return {
        "A_x": _A_in["x"],
        "A_wqkv": _A_in["wqkv"],
        "A_w_phi": _A_in["w_phi"],
        "A_wo": _A_in["wo"],
        "B_x": _B_in["x"],
        "B_w_gate": _B_in["w_gate"],
        "B_w_up": _B_in["w_up"],
        "B_w_down": _B_in["w_down"],
    }

def reference(A_x, A_wqkv, A_w_phi, A_wo, B_x, B_w_gate, B_w_up, B_w_down):
    def _A_ref(x, wqkv, w_phi, wo):
        B, S, D = x.shape
        H = 32; Dh = D // H
        qkv = (lambda x, *d: x.permute(*d))((x @ wqkv).reshape(B, S, 3, H, Dh), 2, 0, 3, 1, 4)
        q, k, v = qkv[0], qkv[1], qkv[2]
        pq = torch.einsum("bhsd,hdf->bhsf", q, w_phi)
        pk = torch.einsum("bhsd,hdf->bhsf", k, w_phi)
        phi_q = torch.concatenate([_softmax(pq, axis=-1), _softmax(-pq, axis=-1)], axis=-1)
        phi_k = torch.concatenate([_softmax(pk, axis=-1), _softmax(-pk, axis=-1)], axis=-1)
        kv = torch.einsum("bhsf,bhsd->bhfd", phi_k, v)
        z  = torch.einsum("bhsf->bhf", phi_k)
        num = torch.einsum("bhqf,bhfd->bhqd", phi_q, kv)
        den = torch.einsum("bhqf,bhf->bhq", phi_q, z)[..., None] + 1e-6
        o = num / den
        return (lambda x, *d: x.permute(*d))(o, 0, 2, 1, 3).reshape(B, S, D) @ wo

    def _B_ref(x, w_gate, w_up, w_down):
        g = torch.einsum("bsd,df->bsf", x, w_gate)
        u = torch.einsum("bsd,df->bsf", x, w_up)
        h = g * u
        return torch.einsum("bsf,fd->bsd", h, w_down)

    x = A_x
    h = x + _A_ref(_layernorm(x, axis=-1), A_wqkv, A_w_phi, A_wo)
    h2 = h + _B_ref(_layernorm(h, axis=-1), B_w_gate, B_w_up, B_w_down)
    return h2
```

```asm
; @launch grid=(256,1,1) block=(256,1,1) lds=163840
.amdgcn_target "amdgcn-amd-amdhsa--gfx950"
.text
.globl sequential_preLN__linear_kernel_hedgehog__glu_gated_bilinear__prompt_kernel
.p2align 8
.type sequential_preLN__linear_kernel_hedgehog__glu_gated_bilinear__prompt_kernel,@function
sequential_preLN__linear_kernel_hedgehog__glu_gated_bilinear__prompt_kernel:
    s_cmpk_ge_u32 s2, 256
    s_cbranch_scc1 L_END
    s_load_dwordx2 s[8:9], s[0:1], 0
    s_load_dwordx2 s[12:13], s[0:1], 8
    v_lshrrev_b32 v2, 6, v0
    s_lshr_b32 s50, s2, 3
    s_and_b32 s49, s2, 7
    v_readfirstlane_b32 s48, v2
    s_getpc_b64 s[4:5]
L_PC:
    v_cmp_gt_u32 vcc, 8, v0
    s_lshl_b32 s72, s50, 3
    s_and_saveexec_b64 s[6:7], vcc
    s_cbranch_execz L_PCE
    v_add_lshl_u32 v31, v0, s72, 7
    v_min_u32 v31, L_END-L_PC, v31
    global_load_dword a200, v31, s[4:5]
L_PCE:
    s_mov_b64 exec, s[6:7]
    v_and_b32 v1, 63, v0
    s_and_b32 s72, s50, 1
    s_lshl1_add_u32 s51, s49, s72
    s_lshr_b32 s52, s2, 4
    s_lshl2_add_u32 s53, s50, s52
    s_lshl2_add_u32 s64, s51, s48
    s_lshl_b32 s64, s64, 15
    s_lshl_b32 s10, 1, 21
    s_lshl_b32 s11, 1, 17
    v_lshrrev_b32 v8, 3, v1
    v_lshrrev_b32 v9, 4, v1
    v_and_b32 v10, 7, v1
    v_xor_b32 v10, v10, v9
    v_lshlrev_b32 v10, 4, v10
    v_lshl_add_u32 v3, v8, 10, v10
    s_add_u32 s66, s48, 4
    s_lshl_b32 s66, s66, 14
    s_and_b32 s73, s53, 7
    s_lshl_b32 s73, s73, 7
    s_mov_b32 m0, s66
    s_add_u32 s73, s73, s64
    v_xor_b32 v4, 64, v3
    s_waitcnt lgkmcnt(0)
    buffer_load_dwordx4 v3, s[8:11], s73 offen lds
    v_add_u32 v4, 7168, v4
    v_add_u32 v5, 14336, v3
    buffer_load_dwordx4 v4, s[8:11], s73 offen offset:1024 lds
    v_add_u32 v6, 14336, v4
    buffer_load_dwordx4 v5, s[8:11], s73 offen offset:2048 lds
    buffer_load_dwordx4 v6, s[8:11], s73 offen offset:3072 lds
    v_lshrrev_b32 v8, 2, v1
    v_mul_u32_u24 v8, 3072, v8
    v_and_b32 v9, 3, v1
    v_lshl_add_u32 v7, v9, 4, v8
    s_lshl_b32 s14, 3, 19
    s_mov_b32 s15, s11
    s_mul_i32 s65, s48, 49152
    s_add_u32 s73, s52, 16
    s_lshl_b32 s73, s73, 6
    s_add_u32 s65, s65, s73
    s_lshl_b32 s67, s48, 11
    v_and_b32 v28, 3, v1
    v_mul_u32_u24 v28, 3072, v28
    v_lshrrev_b32 v29, 2, v1
    v_lshl_add_u32 v28, v29, 10, v28
    s_lshl2_add_u32 s74, s50, s48
    s_mul_i32 s75, s74, 12288
    s_mov_b64 exec, 4080
    buffer_load_dword a200, v28, s[12:15], s75 offen offset:384
    s_mov_b64 exec, 3
    v_lshlrev_b32 v28, 10, v1
    s_lshl_b32 s74, s74, 11
    s_lshl_b32 s75, s49, 18
    s_add_u32 s74, s74, s75
    buffer_load_dword a200, v28, s[8:11], s74 offen offset:384
    s_mov_b64 exec, -1
    s_add_u32 s72, s53, 0
    s_and_b32 s72, s72, 7
    s_mul_i32 s72, s72, 196608
    s_add_u32 m0, s67, 0
    s_add_u32 s72, s72, s65
    buffer_load_dwordx4 v7, s[12:15], s72 offen lds
    buffer_load_dwordx4 v7, s[12:15], s72 offen offset:1024 lds
    s_add_u32 s72, s53, 1
    s_and_b32 s72, s72, 7
    s_mul_i32 s72, s72, 196608
    s_add_u32 m0, s67, 8192
    s_add_u32 s72, s72, s65
    buffer_load_dwordx4 v7, s[12:15], s72 offen lds
    buffer_load_dwordx4 v7, s[12:15], s72 offen offset:1024 lds
    s_add_u32 s72, s53, 2
    s_and_b32 s72, s72, 7
    s_mul_i32 s72, s72, 196608
    s_add_u32 m0, s67, 16384
    s_add_u32 s72, s72, s65
    buffer_load_dwordx4 v7, s[12:15], s72 offen lds
    buffer_load_dwordx4 v7, s[12:15], s72 offen offset:1024 lds
    s_load_dwordx2 s[16:17], s[0:1], 16
    s_load_dwordx2 s[40:41], s[0:1], 80
    s_load_dwordx2 s[44:45], s[0:1], 72
    s_load_dwordx2 s[20:21], s[0:1], 24
    s_load_dwordx2 s[24:25], s[0:1], 40
    s_load_dwordx2 s[28:29], s[0:1], 48
    s_load_dwordx2 s[32:33], s[0:1], 56
    s_load_dwordx2 s[36:37], s[0:1], 64
    s_waitcnt lgkmcnt(0)
    s_mov_b32 s22, 524288
    s_mov_b32 s23, s11
    s_mov_b32 s26, 1835008
    s_mov_b32 s27, s11
    s_mov_b32 s30, 1835008
    s_mov_b32 s31, s11
    s_mov_b32 s34, 1835008
    s_mov_b32 s35, s11
    s_mov_b32 s38, 2097152
    s_mov_b32 s39, s11
    s_mov_b32 s42, 268435456
    s_mov_b32 s43, s11
    s_mov_b32 s46, 256
    s_mov_b32 s47, s11
    s_or_b32 s72, s2, s48
    s_cmp_lg_u32 s72, 0
    s_cbranch_scc1 L_NONCE
    s_memrealtime s[74:75]
    s_waitcnt lgkmcnt(0)
    s_or_b32 s74, s74, 1
    s_and_b32 s75, s75, 0x0fffffff
    v_mov_b32 v28, s74
    v_mov_b32 v29, s75
    s_mov_b64 exec, 1
    buffer_store_dwordx2 v[28:29], off, s[44:47], 0 sc1
    s_mov_b64 exec, -1
L_NONCE:
    s_mov_b32 s58, 0xffff0000
    s_mov_b32 s59, 0xffff0000
    s_mov_b32 s60, 0
    s_mov_b32 s61, -1
    s_mov_b32 s62, 0x3f803f80
    s_mov_b32 s63, 0xffff0000
    s_mov_b32 s69, 0x00003f80
    s_mov_b32 s70, 0x3f800000
    s_mul_i32 s97, s49, 917504
    s_add_u32 s97, s97, 6291456
    s_lshl_b32 s89, s49, 18
    s_add_u32 s89, s89, 0x100000
    s_getreg_b32 s96, hwreg(HW_REG_XCC_ID, 0, 4)
    s_and_b32 s72, s50, 1
    s_lshl_b32 s56, s72, 1
    s_and_b32 s72, s52, 1
    s_add_u32 s56, s56, s72
    s_lshr_b32 s57, s52, 1
    s_and_b32 s72, s57, 3
    s_cmp_eq_u32 s72, 3
    s_cselect_b32 s72, 4, 0
    s_xor_b32 s57, s57, s72
    s_min_u32 s68, s50, 27
    s_mul_i32 s71, s48, 114688
    s_lshl_b32 s72, s68, 7
    s_add_u32 s71, s71, s72
    s_lshl_b32 s78, s48, 12
    v_lshlrev_b32 v2, 4, v1
    v_and_b32 v24, 31, v1
    v_lshrrev_b32 v25, 5, v1
    v_bfe_u32 v26, v1, 1, 3
    v_xor_b32 v26, v26, v25
    v_lshlrev_b32 v26, 4, v26
    v_lshlrev_b32 v24, 7, v24
    v_add_u32 v24, s66, v24
    v_bfe_u32 v27, v1, 2, 2
    v_lshl_add_u32 v27, v25, 3, v27
    v_lshlrev_b32 v27, 6, v27
    v_bfe_u32 v28, v1, 4, 1
    v_lshl_add_u32 v27, v28, 5, v27
    v_and_b32 v29, 3, v1
    v_lshl_add_u32 v27, v29, 3, v27
    s_add_u32 s72, s48, 0
    s_and_b32 s72, s72, 3
    s_lshl_b32 s73, s72, 5
    s_lshl_b32 s72, s72, 11
    v_xor_b32 v30, s73, v26
    v_add_u32 v8, v24, v30
    v_add_u32 v12, s72, v27
    s_add_u32 s72, s48, 1
    s_and_b32 s72, s72, 3
    s_lshl_b32 s73, s72, 5
    s_lshl_b32 s72, s72, 11
    v_xor_b32 v30, s73, v26
    v_add_u32 v9, v24, v30
    v_add_u32 v13, s72, v27
    s_add_u32 s72, s48, 2
    s_and_b32 s72, s72, 3
    s_lshl_b32 s73, s72, 5
    s_lshl_b32 s72, s72, 11
    v_xor_b32 v30, s73, v26
    v_add_u32 v10, v24, v30
    v_add_u32 v14, s72, v27
    s_add_u32 s72, s48, 3
    s_and_b32 s72, s72, 3
    s_lshl_b32 s73, s72, 5
    s_lshl_b32 s72, s72, 11
    v_xor_b32 v30, s73, v26
    v_add_u32 v11, v24, v30
    v_add_u32 v15, s72, v27
    v_bfe_u32 v28, v1, 2, 2
    v_lshl_add_u32 v28, v25, 2, v28
    v_lshlrev_b32 v28, 5, v28
    v_lshl_add_u32 v28, v29, 3, v28
    s_lshl_b32 s72, s48, 10
    s_add_u32 s72, s72, 131072
    v_add_u32 v22, s72, v28
    v_mov_b32 v18, 0
    v_mov_b32 v19, 0
    v_lshrrev_b32 v30, 2, v1
    v_xor_b32 v30, v30, v1
    v_and_b32 v30, 4, v30
    v_mov_b32 v31, s62
    v_cmp_eq_u32 vcc, 0, v30
    s_nop 1
    v_cndmask_b32 v32, 0, v31, vcc
    v_cndmask_b32 v33, 0, v31, vcc
    v_cndmask_b32 v34, 0, v31, vcc
    v_cndmask_b32 v35, 0, v31, vcc
    v_lshlrev_b32 v55, 7, v1
    s_lshl2_add_u32 s99, s2, s48
    s_mulk_i32 s99, 1792
    s_mov_b32 s88, s99
    v_lshrrev_b32 v29, 3, v1
    v_mul_u32_u24 v29, 3584, v29
    v_bfe_u32 v30, v1, 4, 1
    v_lshlrev_b32 v30, 1, v30
    v_and_b32 v31, 7, v1
    v_xor_b32 v30, v30, v31
    v_lshl_add_u32 v48, v30, 4, v29
    v_xor_b32 v30, 4, v30
    v_lshl_add_u32 v49, v30, 4, v29
    s_add_u32 s73, s53, 1
    s_and_b32 s73, s73, 7
    s_lshl_b32 s73, s73, 7
    s_add_u32 m0, s66, 4096
    s_add_u32 s73, s73, s64
    buffer_load_dwordx4 v3, s[8:11], s73 offen lds
    buffer_load_dwordx4 v4, s[8:11], s73 offen offset:1024 lds
    buffer_load_dwordx4 v5, s[8:11], s73 offen offset:2048 lds
    buffer_load_dwordx4 v6, s[8:11], s73 offen offset:3072 lds
    s_add_u32 s72, s53, 3
    s_and_b32 s72, s72, 7
    s_mul_i32 s72, s72, 196608
    s_add_u32 m0, s67, 24576
    s_add_u32 s72, s72, s65
    buffer_load_dwordx4 v7, s[12:15], s72 offen lds
    buffer_load_dwordx4 v7, s[12:15], s72 offen offset:1024 lds
    s_movk_i32 s18, 16384
    s_mov_b32 s19, s11
    s_lshl_b32 s72, s48, 10
    s_add_u32 m0, s72, 131072
    s_lshl_b32 s72, s52, 10
    buffer_load_dwordx4 v2, s[16:19], s72 offen lds
    s_add_u32 s73, s53, 2
    s_and_b32 s73, s73, 7
    s_lshl_b32 s73, s73, 7
    s_add_u32 m0, s66, 8192
    s_add_u32 s73, s73, s64
    buffer_load_dwordx4 v3, s[8:11], s73 offen lds
    buffer_load_dwordx4 v4, s[8:11], s73 offen offset:1024 lds
    buffer_load_dwordx4 v5, s[8:11], s73 offen offset:2048 lds
    buffer_load_dwordx4 v6, s[8:11], s73 offen offset:3072 lds
    s_add_u32 s72, s53, 4
    s_and_b32 s72, s72, 7
    s_mul_i32 s72, s72, 196608
    s_add_u32 m0, s67, 32768
    s_add_u32 s72, s72, s65
    buffer_load_dwordx4 v7, s[12:15], s72 offen lds
    buffer_load_dwordx4 v7, s[12:15], s72 offen offset:1024 lds
    v_and_b32 v28, 7, v1
    v_bfe_u32 v29, v1, 3, 1
    v_lshlrev_b32 v30, 7, v28
    v_mov_b32 v28, v30
    v_lshl_add_u32 v28, v29, 14, v28
    s_lshl_b32 s72, s52, 16
    s_lshl_b32 s73, s51, 10
    s_add_u32 s73, s72, s73
    v_add_u32 v28, s73, v28
    s_lshr_b32 s73, s51, 2
    s_lshl_b32 s73, s73, 10
    s_add_u32 s72, s72, s73
    s_add_u32 s72, s72, 32768
    s_and_b32 s73, s51, 3
    s_lshl_b32 s73, s73, 8
    s_add_u32 s72, s72, s73
    s_cmp_gt_u32 s73, 256
    s_cselect_b32 s76, 0, 0
    s_add_u32 s76, s76, s72
    v_writelane_b32 v28, s76, 16
    s_cmp_gt_u32 s73, 0
    s_cselect_b32 s76, 0, 0
    s_add_u32 s76, s76, s72
    s_add_u32 s76, s76, 128
    v_writelane_b32 v28, s76, 17
    s_lshl_b32 s73, s51, 8
    s_lshl_b32 s72, s52, 12
    s_add_u32 s72, s72, s73
    s_add_u32 s72, s72, 25165824
    v_writelane_b32 v28, s72, 18
    s_add_u32 s72, s72, 128
    v_writelane_b32 v28, s72, 19
    s_lshl_b32 s72, s49, 5
    s_add_u32 s72, s72, s50
    s_lshl_b32 s72, s72, 7
    s_add_u32 s72, s72, 25427968
    v_writelane_b32 v28, s72, 20
    s_sub_u32 s72, s72, 65536
    v_writelane_b32 v28, s72, 21
    s_sub_u32 s72, s72, 65536
    v_writelane_b32 v28, s72, 22
    s_lshl4_add_u32 s72, s51, s52
    s_lshl_b32 s72, s72, 7
    s_add_u32 s72, s72, 25231360
    v_writelane_b32 v28, s72, 23
    s_lshl2_add_u32 s72, s49, s48
    s_lshl_b32 s72, s72, 5
    s_add_u32 s72, s72, s50
    s_lshl_b32 s72, s72, 7
    s_add_u32 s72, s72, 25493504
    v_writelane_b32 v28, s72, 24
    s_mov_b32 s73, 0x1000000
    s_cmp_eq_u32 s48, 3
    s_cselect_b32 s72, 0x1ffffff, s73
    s_mov_b32 exec_hi, 0
    s_mov_b32 exec_lo, s72
    buffer_load_dword a200, v28, s[40:43], 0 offen
    s_mov_b64 exec, -1
    s_waitcnt vmcnt(16)
    s_barrier
    ds_read_b64_tr_b16 a[160:161], v12 offset:0
    ds_read_b64_tr_b16 a[162:163], v12 offset:256
    ds_read_b64_tr_b16 a[164:165], v12 offset:1024
    ds_read_b64_tr_b16 a[166:167], v12 offset:1280
    ds_read_b128 v[128:131], v8 offset:0
    ds_read_b128 v[132:135], v9 offset:0
    ds_read_b128 v[136:139], v10 offset:0
    ds_read_b128 v[140:143], v11 offset:0
    ds_read_b64_tr_b16 a[168:169], v12 offset:8192
    ds_read_b64_tr_b16 a[170:171], v12 offset:8448
    ds_read_b64_tr_b16 a[172:173], v12 offset:9216
    ds_read_b64_tr_b16 a[174:175], v12 offset:9472
    ds_read_b64_tr_b16 a[64:65], v13 offset:0
    ds_read_b64_tr_b16 a[66:67], v13 offset:256
    ds_read_b64_tr_b16 a[68:69], v13 offset:1024
    ds_read_b64_tr_b16 a[70:71], v13 offset:1280
    ds_read_b64_tr_b16 a[72:73], v14 offset:0
    ds_read_b64_tr_b16 a[74:75], v14 offset:256
    ds_read_b64_tr_b16 a[76:77], v14 offset:1024
    ds_read_b64_tr_b16 a[78:79], v14 offset:1280
    ds_read_b64_tr_b16 a[80:81], v15 offset:0
    ds_read_b64_tr_b16 a[82:83], v15 offset:256
    ds_read_b64_tr_b16 a[84:85], v15 offset:1024
    ds_read_b64_tr_b16 a[86:87], v15 offset:1280
    s_waitcnt lgkmcnt(15)
    v_dot2c_f32_bf16 v18, v128, v128
    v_dot2c_f32_bf16 v19, v129, v129
    v_dot2c_f32_bf16 v18, v130, v130
    v_dot2c_f32_bf16 v19, v131, v131
    v_dot2c_f32_bf16 v18, v132, v132
    v_dot2c_f32_bf16 v19, v133, v133
    v_dot2c_f32_bf16 v18, v134, v134
    v_dot2c_f32_bf16 v19, v135, v135
    v_dot2c_f32_bf16 v18, v136, v136
    v_dot2c_f32_bf16 v19, v137, v137
    v_dot2c_f32_bf16 v18, v138, v138
    v_dot2c_f32_bf16 v19, v139, v139
    v_dot2c_f32_bf16 v18, v140, v140
    v_dot2c_f32_bf16 v19, v141, v141
    v_dot2c_f32_bf16 v18, v142, v142
    v_dot2c_f32_bf16 v19, v143, v143
    s_waitcnt vmcnt(10) lgkmcnt(0)
    s_barrier
    v_mfma_f32_16x16x32_bf16 v[40:43], v[32:35], a[160:163], 0
    ds_read_b128 v[144:147], v8 offset:4096
    ds_read_b128 v[148:151], v9 offset:4096
    ds_read_b128 v[152:155], v10 offset:4096
    v_mfma_f32_16x16x32_bf16 v[44:47], v[32:35], a[164:167], 0
    ds_read_b128 v[156:159], v11 offset:4096
    ds_read_b64_tr_b16 a[176:177], v12 offset:16384
    v_mfma_f32_32x32x16_bf16 v[64:79], a[160:163], v[128:131], 0
    ds_read_b64_tr_b16 a[178:179], v12 offset:16640
    ds_read_b64_tr_b16 a[180:181], v12 offset:17408
    v_mfma_f32_32x32x16_bf16 v[80:95], a[164:167], v[128:131], 0
    ds_read_b64_tr_b16 a[182:183], v12 offset:17664
    ds_read_b64_tr_b16 a[88:89], v13 offset:8192
    v_mfma_f32_16x16x32_bf16 v[36:39], v[32:35], v[128:131], 0
    ds_read_b64_tr_b16 a[90:91], v13 offset:8448
    ds_read_b64_tr_b16 a[92:93], v13 offset:9216
    ds_read_b64_tr_b16 a[94:95], v13 offset:9472
    v_mfma_f32_32x32x16_bf16 v[64:79], a[64:67], v[132:135], v[64:79]
    ds_read_b64_tr_b16 a[96:97], v14 offset:8192
    ds_read_b64_tr_b16 a[98:99], v14 offset:8448
    v_mfma_f32_32x32x16_bf16 v[80:95], a[68:71], v[132:135], v[80:95]
    ds_read_b64_tr_b16 a[100:101], v14 offset:9216
    ds_read_b64_tr_b16 a[102:103], v14 offset:9472
    v_mfma_f32_16x16x32_bf16 v[36:39], v[32:35], v[132:135], v[36:39]
    ds_read_b64_tr_b16 a[104:105], v15 offset:8192
    ds_read_b64_tr_b16 a[106:107], v15 offset:8448
    v_mfma_f32_32x32x16_bf16 v[64:79], a[72:75], v[136:139], v[64:79]
    ds_read_b64_tr_b16 a[108:109], v15 offset:9216
    ds_read_b64_tr_b16 a[110:111], v15 offset:9472
    s_add_u32 s73, s53, 3
    v_mfma_f32_32x32x16_bf16 v[80:95], a[76:79], v[136:139], v[80:95]
    s_and_b32 s73, s73, 7
    s_lshl_b32 s73, s73, 7
    v_mfma_f32_16x16x32_bf16 v[36:39], v[32:35], v[136:139], v[36:39]
    s_add_u32 m0, s66, 12288
    s_add_u32 s73, s73, s64
    v_mfma_f32_32x32x16_bf16 v[64:79], a[80:83], v[140:143], v[64:79]
    buffer_load_dwordx4 v3, s[8:11], s73 offen lds
    buffer_load_dwordx4 v4, s[8:11], s73 offen offset:1024 lds
    v_mfma_f32_32x32x16_bf16 v[80:95], a[84:87], v[140:143], v[80:95]
    buffer_load_dwordx4 v5, s[8:11], s73 offen offset:2048 lds
    buffer_load_dwordx4 v6, s[8:11], s73 offen offset:3072 lds
    s_add_u32 s72, s53, 5
    v_mfma_f32_16x16x32_bf16 v[36:39], v[32:35], v[140:143], v[36:39]
    s_and_b32 s72, s72, 7
    s_mul_i32 s72, s72, 196608
    v_mfma_f32_16x16x32_bf16 v[40:43], v[32:35], a[168:171], v[40:43]
    s_add_u32 m0, s67, 40960
    s_add_u32 s72, s72, s65
    v_mfma_f32_16x16x32_bf16 v[44:47], v[32:35], a[172:175], v[44:47]
    buffer_load_dwordx4 v7, s[12:15], s72 offen lds
    buffer_load_dwordx4 v7, s[12:15], s72 offen offset:1024 lds
    s_waitcnt lgkmcnt(15)
    v_dot2c_f32_bf16 v18, v144, v144
    v_dot2c_f32_bf16 v19, v145, v145
    v_dot2c_f32_bf16 v18, v146, v146
    v_dot2c_f32_bf16 v19, v147, v147
    v_dot2c_f32_bf16 v18, v148, v148
    v_dot2c_f32_bf16 v19, v149, v149
    v_dot2c_f32_bf16 v18, v150, v150
    v_dot2c_f32_bf16 v19, v151, v151
    v_dot2c_f32_bf16 v18, v152, v152
    v_dot2c_f32_bf16 v19, v153, v153
    v_dot2c_f32_bf16 v18, v154, v154
    v_dot2c_f32_bf16 v19, v155, v155
    v_dot2c_f32_bf16 v18, v156, v156
    v_dot2c_f32_bf16 v19, v157, v157
    v_dot2c_f32_bf16 v18, v158, v158
    v_dot2c_f32_bf16 v19, v159, v159
    s_waitcnt vmcnt(9) lgkmcnt(0)
    s_barrier
    v_mfma_f32_32x32x16_bf16 v[64:79], a[168:171], v[144:147], v[64:79]
    ds_read_b128 v[160:163], v8 offset:8192
    ds_read_b128 v[164:167], v9 offset:8192
    ds_read_b128 v[168:171], v10 offset:8192
    ds_read_b128 v[172:175], v11 offset:8192
    ds_read_b64_tr_b16 a[160:161], v12 offset:24576
    v_mfma_f32_32x32x16_bf16 v[80:95], a[172:175], v[144:147], v[80:95]
    ds_read_b64_tr_b16 a[162:163], v12 offset:24832
    ds_read_b64_tr_b16 a[164:165], v12 offset:25600
    ds_read_b64_tr_b16 a[166:167], v12 offset:25856
    ds_read_b64_tr_b16 a[64:65], v13 offset:16384
    v_mfma_f32_16x16x32_bf16 v[36:39], v[32:35], v[144:147], v[36:39]
    ds_read_b64_tr_b16 a[66:67], v13 offset:16640
    ds_read_b64_tr_b16 a[68:69], v13 offset:17408
    ds_read_b64_tr_b16 a[70:71], v13 offset:17664
    ds_read_b64_tr_b16 a[72:73], v14 offset:16384
    ds_read_b64_tr_b16 a[74:75], v14 offset:16640
    v_mfma_f32_32x32x16_bf16 v[64:79], a[88:91], v[148:151], v[64:79]
    ds_read_b64_tr_b16 a[76:77], v14 offset:17408
    ds_read_b64_tr_b16 a[78:79], v14 offset:17664
    ds_read_b64_tr_b16 a[80:81], v15 offset:16384
    ds_read_b64_tr_b16 a[82:83], v15 offset:16640
    v_mfma_f32_32x32x16_bf16 v[80:95], a[92:95], v[148:151], v[80:95]
    ds_read_b64_tr_b16 a[84:85], v15 offset:17408
    ds_read_b64_tr_b16 a[86:87], v15 offset:17664
    s_add_u32 s73, s53, 4
    s_and_b32 s73, s73, 7
    v_mfma_f32_16x16x32_bf16 v[36:39], v[32:35], v[148:151], v[36:39]
    s_lshl_b32 s73, s73, 7
    s_add_u32 m0, s66, 0
    s_add_u32 s73, s73, s64
    buffer_load_dwordx4 v3, s[8:11], s73 offen lds
    buffer_load_dwordx4 v4, s[8:11], s73 offen offset:1024 lds
    v_mfma_f32_32x32x16_bf16 v[64:79], a[96:99], v[152:155], v[64:79]
    buffer_load_dwordx4 v5, s[8:11], s73 offen offset:2048 lds
    buffer_load_dwordx4 v6, s[8:11], s73 offen offset:3072 lds
    s_add_u32 s72, s53, 6
    s_and_b32 s72, s72, 7
    v_mfma_f32_32x32x16_bf16 v[80:95], a[100:103], v[152:155], v[80:95]
    s_mul_i32 s72, s72, 196608
    s_add_u32 m0, s67, 49152
    s_add_u32 s72, s72, s65
    buffer_load_dwordx4 v7, s[12:15], s72 offen lds
    v_mfma_f32_16x16x32_bf16 v[36:39], v[32:35], v[152:155], v[36:39]
    buffer_load_dwordx4 v7, s[12:15], s72 offen offset:1024 lds
    ds_read_b64_tr_b16 v[112:113], v22 offset:0
    ds_read_b64_tr_b16 v[114:115], v22 offset:256
    ds_read_b64_tr_b16 v[116:117], v22 offset:512
    ds_read_b64_tr_b16 v[118:119], v22 offset:768
    v_mfma_f32_32x32x16_bf16 v[64:79], a[104:107], v[156:159], v[64:79]
    s_add_u32 s76, s48, 0
    s_and_b32 s76, s76, 3
    s_lshl_b32 s76, s76, 10
    s_sub_u32 s76, 131072, s76
    v_mfma_f32_32x32x16_bf16 v[80:95], a[108:111], v[156:159], v[80:95]
    v_add_u32 v50, s76, v12
    s_add_u32 s76, s48, 1
    s_and_b32 s76, s76, 3
    s_lshl_b32 s76, s76, 10
    v_mfma_f32_16x16x32_bf16 v[36:39], v[32:35], v[156:159], v[36:39]
    s_sub_u32 s76, 131072, s76
    v_add_u32 v51, s76, v13
    s_add_u32 s76, s48, 2
    s_and_b32 s76, s76, 3
    s_lshl_b32 s76, s76, 10
    v_mfma_f32_16x16x32_bf16 v[40:43], v[32:35], a[176:179], v[40:43]
    s_sub_u32 s76, 131072, s76
    v_add_u32 v52, s76, v14
    s_add_u32 s76, s48, 3
    s_and_b32 s76, s76, 3
    v_mfma_f32_16x16x32_bf16 v[44:47], v[32:35], a[180:183], v[44:47]
    s_lshl_b32 s76, s76, 10
    s_sub_u32 s76, 131072, s76
    v_add_u32 v53, s76, v15
    s_lshl2_add_u32 s76, s50, s48
    s_mul_i32 s76, s76, 12288
    v_mul_u32_u24 v31, 3072, v1
    s_mov_b64 exec, 15
    buffer_load_dword a200, v31, s[12:15], s76 offen offset:384
    s_mov_b64 exec, -1
    s_waitcnt lgkmcnt(15)
    v_dot2c_f32_bf16 v18, v160, v160
    v_dot2c_f32_bf16 v19, v161, v161
    v_dot2c_f32_bf16 v18, v162, v162
    v_dot2c_f32_bf16 v19, v163, v163
    v_dot2c_f32_bf16 v18, v164, v164
    v_dot2c_f32_bf16 v19, v165, v165
    v_dot2c_f32_bf16 v18, v166, v166
    v_dot2c_f32_bf16 v19, v167, v167
    v_dot2c_f32_bf16 v18, v168, v168
    v_dot2c_f32_bf16 v19, v169, v169
    v_dot2c_f32_bf16 v18, v170, v170
    v_dot2c_f32_bf16 v19, v171, v171
    v_dot2c_f32_bf16 v18, v172, v172
    v_dot2c_f32_bf16 v19, v173, v173
    v_dot2c_f32_bf16 v18, v174, v174
    v_dot2c_f32_bf16 v19, v175, v175
    s_waitcnt vmcnt(9) lgkmcnt(0)
    s_barrier
    v_mfma_f32_32x32x16_bf16 v[64:79], a[176:179], v[160:163], v[64:79]
    ds_read_b128 v[176:179], v8 offset:12288
    ds_read_b128 v[180:183], v9 offset:12288
    ds_read_b128 v[184:187], v10 offset:12288
    ds_read_b128 v[188:191], v11 offset:12288
    v_mfma_f32_32x32x16_bf16 v[80:95], a[180:183], v[160:163], v[80:95]
    ds_read_b64_tr_b16 a[168:169], v12 offset:32768
    ds_read_b64_tr_b16 a[170:171], v12 offset:33024
    ds_read_b64_tr_b16 a[172:173], v12 offset:33792
    v_mfma_f32_16x16x32_bf16 v[36:39], v[32:35], v[160:163], v[36:39]
    ds_read_b64_tr_b16 a[174:175], v12 offset:34048
    ds_read_b64_tr_b16 a[88:89], v13 offset:24576
    ds_read_b64_tr_b16 a[90:91], v13 offset:24832
    v_mfma_f32_32x32x16_bf16 v[64:79], a[64:67], v[164:167], v[64:79]
    ds_read_b64_tr_b16 a[92:93], v13 offset:25600
    ds_read_b64_tr_b16 a[94:95], v13 offset:25856
    ds_read_b64_tr_b16 a[96:97], v14 offset:24576
    v_mfma_f32_32x32x16_bf16 v[80:95], a[68:71], v[164:167], v[80:95]
    ds_read_b64_tr_b16 a[98:99], v14 offset:24832
    ds_read_b64_tr_b16 a[100:101], v14 offset:25600
    ds_read_b64_tr_b16 a[102:103], v14 offset:25856
    v_mfma_f32_16x16x32_bf16 v[36:39], v[32:35], v[164:167], v[36:39]
    ds_read_b64_tr_b16 a[104:105], v15 offset:24576
    ds_read_b64_tr_b16 a[106:107], v15 offset:24832
    ds_read_b64_tr_b16 a[108:109], v15 offset:25600
    v_mfma_f32_32x32x16_bf16 v[64:79], a[72:75], v[168:171], v[64:79]
    ds_read_b64_tr_b16 a[110:111], v15 offset:25856
    s_add_u32 s73, s53, 5
    s_and_b32 s73, s73, 7
    v_mfma_f32_32x32x16_bf16 v[80:95], a[76:79], v[168:171], v[80:95]
    s_lshl_b32 s73, s73, 7
    s_add_u32 m0, s66, 4096
    s_add_u32 s73, s73, s64
    buffer_load_dwordx4 v3, s[8:11], s73 offen lds
    v_mfma_f32_16x16x32_bf16 v[36:39], v[32:35], v[168:171], v[36:39]
    buffer_load_dwordx4 v4, s[8:11], s73 offen offset:1024 lds
    buffer_load_dwordx4 v5, s[8:11], s73 offen offset:2048 lds
    buffer_load_dwordx4 v6, s[8:11], s73 offen offset:3072 lds
    v_mfma_f32_32x32x16_bf16 v[64:79], a[80:83], v[172:175], v[64:79]
    s_add_u32 s72, s53, 7
    s_and_b32 s72, s72, 7
    s_mul_i32 s72, s72, 196608
    v_mfma_f32_32x32x16_bf16 v[80:95], a[84:87], v[172:175], v[80:95]
    s_add_u32 m0, s67, 57344
    s_add_u32 s72, s72, s65
    buffer_load_dwordx4 v7, s[12:15], s72 offen lds
    v_mfma_f32_16x16x32_bf16 v[36:39], v[32:35], v[172:175], v[36:39]
    buffer_load_dwordx4 v7, s[12:15], s72 offen offset:1024 lds
    s_lshl_b32 s76, s48, 12
    s_sub_u32 s76, 137216, s76
    v_mfma_f32_16x16x32_bf16 v[40:43], v[32:35], a[160:163], v[40:43]
    v_add_u32 v54, s76, v12
    v_mov_b32 v122, 0
    v_mov_b32 v123, 0
    v_mfma_f32_16x16x32_bf16 v[44:47], v[32:35], a[164:167], v[44:47]
    v_mov_b32 v126, 0
    v_mov_b32 v127, 0
    s_mov_b64 exec, 16383
    buffer_load_dword a200, v55, s[32:35], s99 offen
    s_mov_b64 exec, -1
    s_waitcnt lgkmcnt(15)
    v_dot2c_f32_bf16 v18, v176, v176
    v_dot2c_f32_bf16 v19, v177, v177
    v_dot2c_f32_bf16 v18, v178, v178
    v_dot2c_f32_bf16 v19, v179, v179
    v_dot2c_f32_bf16 v18, v180, v180
    v_dot2c_f32_bf16 v19, v181, v181
    v_dot2c_f32_bf16 v18, v182, v182
    v_dot2c_f32_bf16 v19, v183, v183
    v_dot2c_f32_bf16 v18, v184, v184
    v_dot2c_f32_bf16 v19, v185, v185
    v_dot2c_f32_bf16 v18, v186, v186
    v_dot2c_f32_bf16 v19, v187, v187
    v_dot2c_f32_bf16 v18, v188, v188
    v_dot2c_f32_bf16 v19, v189, v189
    v_dot2c_f32_bf16 v18, v190, v190
    v_dot2c_f32_bf16 v19, v191, v191
    s_waitcnt vmcnt(10) lgkmcnt(0)
    s_barrier
    v_mfma_f32_32x32x16_bf16 v[64:79], a[160:163], v[176:179], v[64:79]
    ds_read_b128 v[192:195], v8 offset:0
    ds_read_b128 v[196:199], v9 offset:0
    ds_read_b128 v[200:203], v10 offset:0
    v_mfma_f32_32x32x16_bf16 v[80:95], a[164:167], v[176:179], v[80:95]
    ds_read_b128 v[204:207], v11 offset:0
    ds_read_b64_tr_b16 a[176:177], v12 offset:40960
    ds_read_b64_tr_b16 a[178:179], v12 offset:41216
    v_mfma_f32_16x16x32_bf16 v[36:39], v[32:35], v[176:179], v[36:39]
    ds_read_b64_tr_b16 a[180:181], v12 offset:41984
    ds_read_b64_tr_b16 a[182:183], v12 offset:42240
    ds_read_b64_tr_b16 a[64:65], v13 offset:32768
    v_mfma_f32_32x32x16_bf16 v[64:79], a[88:91], v[180:183], v[64:79]
    ds_read_b64_tr_b16 a[66:67], v13 offset:33024
    ds_read_b64_tr_b16 a[68:69], v13 offset:33792
    ds_read_b64_tr_b16 a[70:71], v13 offset:34048
    v_mfma_f32_32x32x16_bf16 v[80:95], a[92:95], v[180:183], v[80:95]
    ds_read_b64_tr_b16 a[72:73], v14 offset:32768
    ds_read_b64_tr_b16 a[74:75], v14 offset:33024
    ds_read_b64_tr_b16 a[76:77], v14 offset:33792
    v_mfma_f32_16x16x32_bf16 v[36:39], v[32:35], v[180:183], v[36:39]
    ds_read_b64_tr_b16 a[78:79], v14 offset:34048
    ds_read_b64_tr_b16 a[80:81], v15 offset:32768
    ds_read_b64_tr_b16 a[82:83], v15 offset:33024
    v_mfma_f32_32x32x16_bf16 v[64:79], a[96:99], v[184:187], v[64:79]
    ds_read_b64_tr_b16 a[84:85], v15 offset:33792
    ds_read_b64_tr_b16 a[86:87], v15 offset:34048
    v_mfma_f32_32x32x16_bf16 v[80:95], a[100:103], v[184:187], v[80:95]
    s_add_u32 s73, s53, 6
    s_and_b32 s73, s73, 7
    s_lshl_b32 s73, s73, 7
    v_mfma_f32_16x16x32_bf16 v[36:39], v[32:35], v[184:187], v[36:39]
    s_add_u32 m0, s66, 8192
    s_add_u32 s73, s73, s64
    buffer_load_dwordx4 v3, s[8:11], s73 offen lds
    v_mfma_f32_32x32x16_bf16 v[64:79], a[104:107], v[188:191], v[64:79]
    buffer_load_dwordx4 v4, s[8:11], s73 offen offset:1024 lds
    buffer_load_dwordx4 v5, s[8:11], s73 offen offset:2048 lds
    buffer_load_dwordx4 v6, s[8:11], s73 offen offset:3072 lds
    v_mfma_f32_32x32x16_bf16 v[80:95], a[108:111], v[188:191], v[80:95]
    s_mov_b32 s76, 0x80008000
    v_mov_b32 v28, s76
    v_cndmask_b32 v28, 0, v28, s[58:59]
    v_mfma_f32_16x16x32_bf16 v[36:39], v[32:35], v[188:191], v[36:39]
    v_xor_b32 v112, v28, v112
    v_xor_b32 v113, v28, v113
    v_xor_b32 v114, v28, v114
    v_mfma_f32_16x16x32_bf16 v[40:43], v[32:35], a[168:171], v[40:43]
    v_xor_b32 v115, v28, v115
    v_xor_b32 v116, v28, v116
    v_xor_b32 v117, v28, v117
    v_mfma_f32_16x16x32_bf16 v[44:47], v[32:35], a[172:175], v[44:47]
    v_xor_b32 v118, v28, v118
    v_xor_b32 v119, v28, v119
    s_waitcnt lgkmcnt(15)
    v_dot2c_f32_bf16 v18, v192, v192
    v_dot2c_f32_bf16 v19, v193, v193
    v_dot2c_f32_bf16 v18, v194, v194
    v_dot2c_f32_bf16 v19, v195, v195
    v_dot2c_f32_bf16 v18, v196, v196
    v_dot2c_f32_bf16 v19, v197, v197
    v_dot2c_f32_bf16 v18, v198, v198
    v_dot2c_f32_bf16 v19, v199, v199
    v_dot2c_f32_bf16 v18, v200, v200
    v_dot2c_f32_bf16 v19, v201, v201
    v_dot2c_f32_bf16 v18, v202, v202
    v_dot2c_f32_bf16 v19, v203, v203
    v_dot2c_f32_bf16 v18, v204, v204
    v_dot2c_f32_bf16 v19, v205, v205
    v_dot2c_f32_bf16 v18, v206, v206
    v_dot2c_f32_bf16 v19, v207, v207
    s_load_dwordx2 s[54:55], s[44:45], 0
    s_waitcnt vmcnt(7) lgkmcnt(0)
    s_barrier
    v_mfma_f32_32x32x16_bf16 v[64:79], a[168:171], v[192:195], v[64:79]
    ds_read_b128 v[208:211], v8 offset:4096
    ds_read_b128 v[212:215], v9 offset:4096
    ds_read_b128 v[216:219], v10 offset:4096
    ds_read_b128 v[220:223], v11 offset:4096
    v_mfma_f32_32x32x16_bf16 v[80:95], a[172:175], v[192:195], v[80:95]
    ds_read_b64_tr_b16 a[160:161], v12 offset:49152
    ds_read_b64_tr_b16 a[162:163], v12 offset:49408
    ds_read_b64_tr_b16 a[164:165], v12 offset:50176
    v_mfma_f32_16x16x32_bf16 v[36:39], v[32:35], v[192:195], v[36:39]
    ds_read_b64_tr_b16 a[166:167], v12 offset:50432
    ds_read_b64_tr_b16 a[88:89], v13 offset:40960
    ds_read_b64_tr_b16 a[90:91], v13 offset:41216
    v_mfma_f32_32x32x16_bf16 v[64:79], a[64:67], v[196:199], v[64:79]
    ds_read_b64_tr_b16 a[92:93], v13 offset:41984
    ds_read_b64_tr_b16 a[94:95], v13 offset:42240
    ds_read_b64_tr_b16 a[96:97], v14 offset:40960
    v_mfma_f32_32x32x16_bf16 v[80:95], a[68:71], v[196:199], v[80:95]
    ds_read_b64_tr_b16 a[98:99], v14 offset:41216
    ds_read_b64_tr_b16 a[100:101], v14 offset:41984
    ds_read_b64_tr_b16 a[102:103], v14 offset:42240
    v_mfma_f32_16x16x32_bf16 v[36:39], v[32:35], v[196:199], v[36:39]
    ds_read_b64_tr_b16 a[104:105], v15 offset:40960
    ds_read_b64_tr_b16 a[106:107], v15 offset:41216
    ds_read_b64_tr_b16 a[108:109], v15 offset:41984
    v_mfma_f32_32x32x16_bf16 v[64:79], a[72:75], v[200:203], v[64:79]
    ds_read_b64_tr_b16 a[110:111], v15 offset:42240
    s_add_u32 s73, s53, 7
    s_and_b32 s73, s73, 7
    v_mfma_f32_32x32x16_bf16 v[80:95], a[76:79], v[200:203], v[80:95]
    s_lshl_b32 s73, s73, 7
    s_add_u32 m0, s66, 12288
    s_add_u32 s73, s73, s64
    v_mfma_f32_16x16x32_bf16 v[36:39], v[32:35], v[200:203], v[36:39]
    buffer_load_dwordx4 v3, s[8:11], s73 offen lds
    buffer_load_dwordx4 v4, s[8:11], s73 offen offset:1024 lds
    buffer_load_dwordx4 v5, s[8:11], s73 offen offset:2048 lds
    v_mfma_f32_32x32x16_bf16 v[64:79], a[80:83], v[204:207], v[64:79]
    buffer_load_dwordx4 v6, s[8:11], s73 offen offset:3072 lds
    s_lshr_b32 s74, s67, 1
    s_sub_u32 s75, s65, 1024
    v_mfma_f32_32x32x16_bf16 v[80:95], a[84:87], v[204:207], v[80:95]
    s_add_u32 s72, s53, 0
    s_and_b32 s72, s72, 7
    s_mul_i32 s72, s72, 196608
    v_mfma_f32_16x16x32_bf16 v[36:39], v[32:35], v[204:207], v[36:39]
    s_add_u32 m0, s74, 131072
    s_add_u32 s72, s72, s75
    buffer_load_dwordx4 v7, s[12:15], s72 offen lds
    v_mfma_f32_16x16x32_bf16 v[40:43], v[32:35], a[176:179], v[40:43]
    s_add_u32 s72, s53, 1
    s_and_b32 s72, s72, 7
    s_mul_i32 s72, s72, 196608
    v_mfma_f32_16x16x32_bf16 v[44:47], v[32:35], a[180:183], v[44:47]
    s_add_u32 m0, s74, 135168
    s_add_u32 s72, s72, s75
    buffer_load_dwordx4 v7, s[12:15], s72 offen lds
    s_waitcnt lgkmcnt(15)
    v_dot2c_f32_bf16 v18, v208, v208
    v_dot2c_f32_bf16 v19, v209, v209
    v_dot2c_f32_bf16 v18, v210, v210
    v_dot2c_f32_bf16 v19, v211, v211
    v_dot2c_f32_bf16 v18, v212, v212
    v_dot2c_f32_bf16 v19, v213, v213
    v_dot2c_f32_bf16 v18, v214, v214
    v_dot2c_f32_bf16 v19, v215, v215
    v_dot2c_f32_bf16 v18, v216, v216
    v_dot2c_f32_bf16 v19, v217, v217
    v_dot2c_f32_bf16 v18, v218, v218
    v_dot2c_f32_bf16 v19, v219, v219
    v_dot2c_f32_bf16 v18, v220, v220
    v_dot2c_f32_bf16 v19, v221, v221
    v_dot2c_f32_bf16 v18, v222, v222
    v_dot2c_f32_bf16 v19, v223, v223
    s_waitcnt vmcnt(6) lgkmcnt(0)
    s_barrier
    v_mfma_f32_32x32x16_bf16 v[64:79], a[176:179], v[208:211], v[64:79]
    ds_read_b128 v[224:227], v8 offset:8192
    ds_read_b128 v[228:231], v9 offset:8192
    ds_read_b128 v[232:235], v10 offset:8192
    ds_read_b128 v[236:239], v11 offset:8192
    ds_read_b64_tr_b16 a[168:169], v12 offset:57344
    ds_read_b64_tr_b16 a[170:171], v12 offset:57600
    v_mfma_f32_32x32x16_bf16 v[80:95], a[180:183], v[208:211], v[80:95]
    ds_read_b64_tr_b16 a[172:173], v12 offset:58368
    ds_read_b64_tr_b16 a[174:175], v12 offset:58624
    ds_read_b64_tr_b16 a[64:65], v13 offset:49152
    ds_read_b64_tr_b16 a[66:67], v13 offset:49408
    ds_read_b64_tr_b16 a[68:69], v13 offset:50176
    v_mfma_f32_16x16x32_bf16 v[36:39], v[32:35], v[208:211], v[36:39]
    ds_read_b64_tr_b16 a[70:71], v13 offset:50432
    ds_read_b64_tr_b16 a[72:73], v14 offset:49152
    ds_read_b64_tr_b16 a[74:75], v14 offset:49408
    ds_read_b64_tr_b16 a[76:77], v14 offset:50176
    ds_read_b64_tr_b16 a[78:79], v14 offset:50432
    ds_read_b64_tr_b16 a[80:81], v15 offset:49152
    v_mfma_f32_32x32x16_bf16 v[64:79], a[88:91], v[212:215], v[64:79]
    ds_read_b64_tr_b16 a[82:83], v15 offset:49408
    ds_read_b64_tr_b16 a[84:85], v15 offset:50176
    ds_read_b64_tr_b16 a[86:87], v15 offset:50432
    s_add_u32 s72, s53, 2
    s_and_b32 s72, s72, 7
    v_mfma_f32_32x32x16_bf16 v[80:95], a[92:95], v[212:215], v[80:95]
    s_mul_i32 s72, s72, 196608
    s_add_u32 m0, s74, 139264
    s_add_u32 s72, s72, s75
    buffer_load_dwordx4 v7, s[12:15], s72 offen lds
    s_add_u32 s72, s53, 3
    s_and_b32 s72, s72, 7
    v_mfma_f32_16x16x32_bf16 v[36:39], v[32:35], v[212:215], v[36:39]
    s_mul_i32 s72, s72, 196608
    s_add_u32 m0, s74, 143360
    s_add_u32 s72, s72, s75
    buffer_load_dwordx4 v7, s[12:15], s72 offen lds
    s_add_u32 s72, s53, 4
    v_mfma_f32_32x32x16_bf16 v[64:79], a[96:99], v[216:219], v[64:79]
    s_and_b32 s72, s72, 7
    s_mul_i32 s72, s72, 196608
    s_add_u32 m0, s74, 147456
    s_add_u32 s72, s72, s75
    buffer_load_dwordx4 v7, s[12:15], s72 offen lds
    s_add_u32 s72, s53, 5
    v_mfma_f32_32x32x16_bf16 v[80:95], a[100:103], v[216:219], v[80:95]
    s_and_b32 s72, s72, 7
    s_mul_i32 s72, s72, 196608
    s_add_u32 m0, s74, 151552
    s_add_u32 s72, s72, s75
    buffer_load_dwordx4 v7, s[12:15], s72 offen lds
    v_mfma_f32_16x16x32_bf16 v[36:39], v[32:35], v[216:219], v[36:39]
    s_add_u32 s72, s53, 6
    s_and_b32 s72, s72, 7
    s_mul_i32 s72, s72, 196608
    s_add_u32 m0, s74, 155648
    s_add_u32 s72, s72, s75
    buffer_load_dwordx4 v7, s[12:15], s72 offen lds
    v_mfma_f32_32x32x16_bf16 v[64:79], a[104:107], v[220:223], v[64:79]
    s_add_u32 s72, s53, 7
    s_and_b32 s72, s72, 7
    s_mul_i32 s72, s72, 196608
    s_add_u32 m0, s74, 159744
    s_add_u32 s72, s72, s75
    v_mfma_f32_32x32x16_bf16 v[80:95], a[108:111], v[220:223], v[80:95]
    buffer_load_dwordx4 v7, s[12:15], s72 offen lds
    v_and_b32 v31, 31, v1
    v_mul_u32_u24 v3, 136, v31
    v_lshl_add_u32 v3, v25, 3, v3
    v_add_u32 v3, s66, v3
    v_mul_u32_u24 v4, 72, v31
    v_mfma_f32_16x16x32_bf16 v[36:39], v[32:35], v[220:223], v[36:39]
    v_lshl_add_u32 v4, v25, 3, v4
    v_add_u32 v4, s66, v4
    v_bfe_u32 v31, v1, 2, 2
    v_lshl_add_u32 v31, v25, 3, v31
    v_bfe_u32 v22, v1, 4, 1
    v_mfma_f32_16x16x32_bf16 v[40:43], v[32:35], a[160:163], v[40:43]
    v_lshlrev_b32 v22, 5, v22
    v_and_b32 v28, 3, v1
    v_lshl_add_u32 v22, v28, 3, v22
    s_lshl_b32 s76, s48, 6
    s_add_u32 s76, s76, 67584
    v_mul_u32_u24 v5, 136, v31
    v_mfma_f32_16x16x32_bf16 v[44:47], v[32:35], a[164:167], v[44:47]
    v_add3_u32 v5, v5, v22, s76
    s_mul_i32 s76, s48, 2304
    s_add_u32 s76, s76, 71936
    v_mul_u32_u24 v6, 72, v31
    v_add3_u32 v6, v6, v22, s76
    s_waitcnt lgkmcnt(15)
    v_dot2c_f32_bf16 v18, v224, v224
    v_dot2c_f32_bf16 v19, v225, v225
    v_dot2c_f32_bf16 v18, v226, v226
    v_dot2c_f32_bf16 v19, v227, v227
    v_dot2c_f32_bf16 v18, v228, v228
    v_dot2c_f32_bf16 v19, v229, v229
    v_dot2c_f32_bf16 v18, v230, v230
    v_dot2c_f32_bf16 v19, v231, v231
    v_dot2c_f32_bf16 v18, v232, v232
    v_dot2c_f32_bf16 v19, v233, v233
    v_dot2c_f32_bf16 v18, v234, v234
    v_dot2c_f32_bf16 v19, v235, v235
    v_dot2c_f32_bf16 v18, v236, v236
    v_dot2c_f32_bf16 v19, v237, v237
    v_dot2c_f32_bf16 v18, v238, v238
    v_dot2c_f32_bf16 v19, v239, v239
    s_waitcnt lgkmcnt(12)
    v_mfma_f32_16x16x32_bf16 v[40:43], v[32:35], a[168:171], v[40:43]
    v_mfma_f32_16x16x32_bf16 v[44:47], v[32:35], a[172:175], v[44:47]
    s_lshl_b32 s72, s48, 2
    s_add_u32 s72, s72, 65536
    v_add_u32 v30, s72, v2
    s_nop 4
    v_cndmask_b32 v20, v40, v44, s[60:61]
    ds_write_b32 v30, v20
    s_waitcnt vmcnt(8) lgkmcnt(0)
    s_barrier
    v_mfma_f32_32x32x16_bf16 v[64:79], a[160:163], v[224:227], v[64:79]
    ds_read_b128 v[240:243], v8 offset:12288
    ds_read_b128 v[244:247], v9 offset:12288
    ds_read_b128 v[248:251], v10 offset:12288
    v_mfma_f32_32x32x16_bf16 v[80:95], a[164:167], v[224:227], v[80:95]
    ds_read_b128 v[252:255], v11 offset:12288
    v_and_b32 v30, 31, v1
    v_lshlrev_b32 v30, 4, v30
    v_mfma_f32_16x16x32_bf16 v[36:39], v[32:35], v[224:227], v[36:39]
    v_add_u32 v30, 65536, v30
    ds_read_b128 v[96:99], v30
    ds_read_b128 v[100:103], v30 offset:512
    v_mfma_f32_32x32x16_bf16 v[64:79], a[64:67], v[228:231], v[64:79]
    ds_read_b64_tr_b16 a[88:89], v13 offset:57344
    ds_read_b64_tr_b16 a[90:91], v13 offset:57600
    ds_read_b64_tr_b16 a[92:93], v13 offset:58368
    v_mfma_f32_32x32x16_bf16 v[80:95], a[68:71], v[228:231], v[80:95]
    ds_read_b64_tr_b16 a[94:95], v13 offset:58624
    ds_read_b64_tr_b16 a[96:97], v14 offset:57344
    ds_read_b64_tr_b16 a[98:99], v14 offset:57600
    v_mfma_f32_16x16x32_bf16 v[36:39], v[32:35], v[228:231], v[36:39]
    ds_read_b64_tr_b16 a[100:101], v14 offset:58368
    ds_read_b64_tr_b16 a[102:103], v14 offset:58624
    ds_read_b64_tr_b16 a[104:105], v15 offset:57344
    v_mfma_f32_32x32x16_bf16 v[64:79], a[72:75], v[232:235], v[64:79]
    ds_read_b64_tr_b16 a[106:107], v15 offset:57600
    ds_read_b64_tr_b16 a[108:109], v15 offset:58368
    ds_read_b64_tr_b16 a[110:111], v15 offset:58624
    v_mfma_f32_32x32x16_bf16 v[80:95], a[76:79], v[232:235], v[80:95]
    s_waitcnt lgkmcnt(12)
    v_add_f32 v96, v96, v97
    v_add_f32 v98, v98, v99
    v_mfma_f32_16x16x32_bf16 v[36:39], v[32:35], v[232:235], v[36:39]
    v_add_f32 v100, v100, v101
    v_add_f32 v102, v102, v103
    v_add_f32 v96, v96, v98
    v_mfma_f32_32x32x16_bf16 v[64:79], a[80:83], v[236:239], v[64:79]
    v_add_f32 v100, v100, v102
    v_mov_b32 v58, 0
    v_mov_b32 v59, 0
    v_mfma_f32_32x32x16_bf16 v[80:95], a[84:87], v[236:239], v[80:95]
    v_cvt_pk_bf16_f32 v125, v96, 0
    v_lshlrev_b32 v30, 16, v125
    v_sub_f32 v30, v96, v30
    v_cvt_pk_bf16_f32 v124, v96, v30
    v_cvt_pk_bf16_f32 v57, v100, 0
    v_lshlrev_b32 v31, 16, v57
    v_sub_f32 v31, v100, v31
    v_cvt_pk_bf16_f32 v56, v100, v31
    s_mov_b64 exec, 16383
    buffer_load_dword a200, v55, s[24:27], s88 offen
    s_mov_b64 exec, -1
    v_mfma_f32_16x16x32_bf16 v[36:39], v[32:35], v[236:239], v[36:39]
    s_mov_b64 exec, 16383
    buffer_load_dword a200, v55, s[28:31], s88 offen
    s_mov_b64 exec, -1
    s_lshl2_add_u32 s76, s2, s48
    s_lshl_b32 s76, s76, 9
    s_mov_b64 exec, 15
    buffer_load_dword a200, v55, s[20:23], s76 offen
    s_mov_b64 exec, -1
    v_dot2c_f32_bf16 v18, v240, v240
    v_dot2c_f32_bf16 v19, v241, v241
    v_dot2c_f32_bf16 v18, v242, v242
    v_dot2c_f32_bf16 v19, v243, v243
    v_dot2c_f32_bf16 v18, v244, v244
    v_dot2c_f32_bf16 v19, v245, v245
    v_dot2c_f32_bf16 v18, v246, v246
    v_dot2c_f32_bf16 v19, v247, v247
    v_dot2c_f32_bf16 v18, v248, v248
    v_dot2c_f32_bf16 v19, v249, v249
    v_dot2c_f32_bf16 v18, v250, v250
    v_dot2c_f32_bf16 v19, v251, v251
    v_dot2c_f32_bf16 v18, v252, v252
    v_dot2c_f32_bf16 v19, v253, v253
    v_dot2c_f32_bf16 v18, v254, v254
    v_dot2c_f32_bf16 v19, v255, v255
    s_waitcnt lgkmcnt(0)
    v_mfma_f32_16x16x32_bf16 v[36:39], v[32:35], v[240:243], v[36:39]
    v_mfma_f32_16x16x32_bf16 v[36:39], v[32:35], v[244:247], v[36:39]
    v_mfma_f32_16x16x32_bf16 v[36:39], v[32:35], v[248:251], v[36:39]
    v_mfma_f32_16x16x32_bf16 v[36:39], v[32:35], v[252:255], v[36:39]
    v_mfma_f32_32x32x16_bf16 v[64:79], a[168:171], v[240:243], v[64:79]
    v_add_f32 v18, v18, v19
    v_mov_b32 v19, v18
    s_nop 0
    s_nop 0
    v_permlane32_swap_b32 v18, v19
    v_mfma_f32_32x32x16_bf16 v[64:79], a[88:91], v[244:247], v[64:79]
    v_add_f32 v18, v18, v19
    v_mul_f32 v23, 0x3b000000, v36
    v_mul_f32 v18, 0x3b000000, v18
    v_fma_f32 v18, -v23, v23, v18
    v_mfma_f32_32x32x16_bf16 v[64:79], a[96:99], v[248:251], v[64:79]
    v_max_f32 v18, 0, v18
    v_add_f32 v18, 0x3727c5ac, v18
    v_rsq_f32 v24, v18
    v_cndmask_b32 v28, -v23, 0, s[60:61]
    v_mfma_f32_32x32x16_bf16 v[64:79], a[104:107], v[252:255], v[64:79]
    v_cvt_pk_bf16_f32 v120, v28, v28
    v_and_b32 v121, s63, v120
    v_sub_f32 v28, v28, v121
    v_cvt_pk_bf16_f32 v121, v28, 0
    s_nop 1
    v_mfma_f32_32x32x16_bf16 v[64:79], v[124:127], v[120:123], v[64:79]
    v_mul_f32 v26, 0x3fb8aa3b, v24
    v_mfma_f32_32x32x16_bf16 v[80:95], a[172:175], v[240:243], v[80:95]
    v_mov_b32 v28, s62
    v_mov_b32 v29, s62
    ds_write_b64 v4, v[28:29] offset:6432
    ds_write_b64 v4, v[28:29] offset:8704
    ds_write_b64 v4, v[28:29] offset:6448
    ds_write_b64 v4, v[28:29] offset:8720
    v_mfma_f32_32x32x16_bf16 v[80:95], a[92:95], v[244:247], v[80:95]
    s_nop 2
    v_cvt_pk_bf16_f32 v104, v64, v65
    v_cvt_pk_bf16_f32 v105, v66, v67
    v_cvt_pk_bf16_f32 v106, v68, v69
    v_cvt_pk_bf16_f32 v107, v70, v71
    v_mfma_f32_32x32x16_bf16 v[80:95], a[100:103], v[248:251], v[80:95]
    v_cvt_pk_bf16_f32 v108, v72, v73
    v_cvt_pk_bf16_f32 v109, v74, v75
    v_cvt_pk_bf16_f32 v110, v76, v77
    v_cvt_pk_bf16_f32 v111, v78, v79
    v_mfma_f32_32x32x16_bf16 v[32:47], v[112:115], v[104:107], 0
    s_nop 0
    v_mfma_f32_32x32x16_bf16 v[64:79], v[116:119], v[108:111], 0
    v_mfma_f32_32x32x16_bf16 v[80:95], a[108:111], v[252:255], v[80:95]
    v_mfma_f32_32x32x16_bf16 v[80:95], v[56:59], v[120:123], v[80:95]
    s_lshl2_add_u32 s76, s50, s48
    s_lshl_b32 s76, s76, 12
    v_lshlrev_b32 v31, 10, v1
    s_mov_b64 exec, 15
    buffer_load_dword a200, v31, s[20:23], s76 offen offset:384
    s_mov_b64 exec, -1
    s_lshl2_add_u32 s76, s50, s48
    s_lshl_b32 s76, s76, 11
    s_add_u32 s76, s76, s97
    s_mov_b64 exec, 0xffff
    buffer_load_dword a200, v55, s[40:43], s76 offen
    s_mov_b64 exec, -1
    s_cmp_gt_u32 s50, 27
    s_cselect_b32 s26, 0, s26
    s_cselect_b32 s30, 0, s30
    v_max3_f32 v96, v32, v33, v34
    v_max3_f32 v97, v40, v41, v42
    v_max3_f32 v98, v64, v65, v66
    v_max3_f32 v99, v72, v73, v74
    v_max3_f32 v96, v96, v35, v36
    v_max3_f32 v97, v97, v43, v44
    v_max3_f32 v98, v98, v67, v68
    v_max3_f32 v99, v99, v75, v76
    v_max3_f32 v96, v96, v37, v38
    v_max3_f32 v97, v97, v45, v46
    v_max3_f32 v98, v98, v69, v70
    v_max3_f32 v99, v99, v77, v78
    v_max_f32 v96, v96, v39
    v_max_f32 v97, v97, v47
    v_max_f32 v98, v98, v71
    v_max_f32 v99, v99, v79
    v_permlane32_swap_b32 v96, v97
    s_nop 0
    v_permlane32_swap_b32 v98, v99
    v_max_f32 v96, v96, v97
    v_max_f32 v98, v98, v99
    v_mov_b32 v97, v96
    v_mov_b32 v99, v98
    s_nop 0
    v_permlane32_swap_b32 v96, v97
    v_permlane32_swap_b32 v98, v99
    v_mul_f32 v100, -v96, v26
    v_mul_f32 v102, -v97, v26
    v_mul_f32 v104, -v98, v26
    v_mul_f32 v106, -v99, v26
    v_pk_fma_f32 v[32:33], v[32:33], v[26:27], v[100:101] op_sel_hi:[1,0,0]
    v_pk_fma_f32 v[34:35], v[34:35], v[26:27], v[100:101] op_sel_hi:[1,0,0]
    v_pk_fma_f32 v[36:37], v[36:37], v[26:27], v[100:101] op_sel_hi:[1,0,0]
    v_pk_fma_f32 v[38:39], v[38:39], v[26:27], v[100:101] op_sel_hi:[1,0,0]
    v_pk_fma_f32 v[40:41], v[40:41], v[26:27], v[102:103] op_sel_hi:[1,0,0]
    v_pk_fma_f32 v[42:43], v[42:43], v[26:27], v[102:103] op_sel_hi:[1,0,0]
    v_pk_fma_f32 v[44:45], v[44:45], v[26:27], v[102:103] op_sel_hi:[1,0,0]
    v_pk_fma_f32 v[46:47], v[46:47], v[26:27], v[102:103] op_sel_hi:[1,0,0]
    v_pk_fma_f32 v[64:65], v[64:65], v[26:27], v[104:105] op_sel_hi:[1,0,0]
    v_pk_fma_f32 v[66:67], v[66:67], v[26:27], v[104:105] op_sel_hi:[1,0,0]
    v_pk_fma_f32 v[68:69], v[68:69], v[26:27], v[104:105] op_sel_hi:[1,0,0]
    v_pk_fma_f32 v[70:71], v[70:71], v[26:27], v[104:105] op_sel_hi:[1,0,0]
    v_pk_fma_f32 v[72:73], v[72:73], v[26:27], v[106:107] op_sel_hi:[1,0,0]
    v_pk_fma_f32 v[74:75], v[74:75], v[26:27], v[106:107] op_sel_hi:[1,0,0]
    v_pk_fma_f32 v[76:77], v[76:77], v[26:27], v[106:107] op_sel_hi:[1,0,0]
    v_pk_fma_f32 v[78:79], v[78:79], v[26:27], v[106:107] op_sel_hi:[1,0,0]
    v_pk_mul_f32 v[80:81], v[80:81], v[24:25] op_sel_hi:[1,0]
    v_pk_mul_f32 v[82:83], v[82:83], v[24:25] op_sel_hi:[1,0]
    v_pk_mul_f32 v[84:85], v[84:85], v[24:25] op_sel_hi:[1,0]
    v_pk_mul_f32 v[86:87], v[86:87], v[24:25] op_sel_hi:[1,0]
    v_pk_mul_f32 v[88:89], v[88:89], v[24:25] op_sel_hi:[1,0]
    v_pk_mul_f32 v[90:91], v[90:91], v[24:25] op_sel_hi:[1,0]
    v_pk_mul_f32 v[92:93], v[92:93], v[24:25] op_sel_hi:[1,0]
    v_pk_mul_f32 v[94:95], v[94:95], v[24:25] op_sel_hi:[1,0]
    v_cvt_pk_bf16_f32 v80, v80, v81
    v_cvt_pk_bf16_f32 v81, v82, v83
    v_cvt_pk_bf16_f32 v82, v84, v85
    v_cvt_pk_bf16_f32 v83, v86, v87
    v_cvt_pk_bf16_f32 v84, v88, v89
    v_cvt_pk_bf16_f32 v85, v90, v91
    v_cvt_pk_bf16_f32 v86, v92, v93
    v_cvt_pk_bf16_f32 v87, v94, v95
    v_exp_f32 v32, v32
    ds_write_b64 v4, v[80:81] offset:6400
    v_exp_f32 v33, v33
    v_exp_f32 v34, v34
    v_exp_f32 v35, v35
    v_exp_f32 v36, v36
    ds_write_b64 v4, v[82:83] offset:6416
    v_exp_f32 v37, v37
    v_exp_f32 v38, v38
    v_exp_f32 v39, v39
    v_exp_f32 v40, v40
    ds_write_b64 v4, v[84:85] offset:8736
    v_exp_f32 v41, v41
    v_exp_f32 v42, v42
    v_exp_f32 v43, v43
    v_exp_f32 v44, v44
    ds_write_b64 v4, v[86:87] offset:8752
    v_exp_f32 v45, v45
    v_exp_f32 v46, v46
    v_exp_f32 v47, v47
    v_exp_f32 v64, v64
    v_exp_f32 v65, v65
    v_exp_f32 v66, v66
    v_exp_f32 v67, v67
    v_exp_f32 v68, v68
    v_exp_f32 v69, v69
    v_exp_f32 v70, v70
    v_exp_f32 v71, v71
    v_exp_f32 v72, v72
    v_exp_f32 v73, v73
    v_exp_f32 v74, v74
    v_exp_f32 v75, v75
    v_exp_f32 v76, v76
    v_exp_f32 v77, v77
    v_exp_f32 v78, v78
    v_exp_f32 v79, v79
    v_pk_add_f32 v[100:101], v[32:33], v[34:35]
    v_pk_add_f32 v[102:103], v[40:41], v[42:43]
    v_pk_add_f32 v[104:105], v[64:65], v[66:67]
    v_pk_add_f32 v[106:107], v[72:73], v[74:75]
    v_pk_add_f32 v[100:101], v[100:101], v[36:37]
    v_pk_add_f32 v[102:103], v[102:103], v[44:45]
    v_pk_add_f32 v[104:105], v[104:105], v[68:69]
    v_pk_add_f32 v[106:107], v[106:107], v[76:77]
    v_pk_add_f32 v[100:101], v[100:101], v[38:39]
    v_pk_add_f32 v[102:103], v[102:103], v[46:47]
    v_pk_add_f32 v[104:105], v[104:105], v[70:71]
    v_pk_add_f32 v[106:107], v[106:107], v[78:79]
    v_add_f32 v96, v100, v101
    v_add_f32 v97, v102, v103
    v_add_f32 v98, v104, v105
    v_add_f32 v99, v106, v107
    v_permlane32_swap_b32 v96, v97
    s_nop 0
    v_permlane32_swap_b32 v98, v99
    v_add_f32 v96, v96, v97
    v_add_f32 v98, v98, v99
    v_mov_b32 v97, v96
    v_mov_b32 v99, v98
    s_nop 0
    v_permlane32_swap_b32 v96, v97
    v_permlane32_swap_b32 v98, v99
    v_rcp_f32 v100, v96
    v_rcp_f32 v102, v97
    v_rcp_f32 v104, v98
    v_rcp_f32 v106, v99
    v_pk_mul_f32 v[32:33], v[32:33], v[100:101] op_sel_hi:[1,0]
    v_pk_mul_f32 v[34:35], v[34:35], v[100:101] op_sel_hi:[1,0]
    v_pk_mul_f32 v[36:37], v[36:37], v[100:101] op_sel_hi:[1,0]
    v_pk_mul_f32 v[38:39], v[38:39], v[100:101] op_sel_hi:[1,0]
    v_pk_mul_f32 v[40:41], v[40:41], v[102:103] op_sel_hi:[1,0]
    v_pk_mul_f32 v[42:43], v[42:43], v[102:103] op_sel_hi:[1,0]
    v_pk_mul_f32 v[44:45], v[44:45], v[102:103] op_sel_hi:[1,0]
    v_pk_mul_f32 v[46:47], v[46:47], v[102:103] op_sel_hi:[1,0]
    v_pk_mul_f32 v[64:65], v[64:65], v[104:105] op_sel_hi:[1,0]
    v_pk_mul_f32 v[66:67], v[66:67], v[104:105] op_sel_hi:[1,0]
    v_pk_mul_f32 v[68:69], v[68:69], v[104:105] op_sel_hi:[1,0]
    v_pk_mul_f32 v[70:71], v[70:71], v[104:105] op_sel_hi:[1,0]
    v_pk_mul_f32 v[72:73], v[72:73], v[106:107] op_sel_hi:[1,0]
    v_pk_mul_f32 v[74:75], v[74:75], v[106:107] op_sel_hi:[1,0]
    v_pk_mul_f32 v[76:77], v[76:77], v[106:107] op_sel_hi:[1,0]
    v_pk_mul_f32 v[78:79], v[78:79], v[106:107] op_sel_hi:[1,0]
    v_cvt_pk_bf16_f32 v32, v32, v33
    v_cvt_pk_bf16_f32 v33, v34, v35
    ds_write_b64 v3, v[32:33] offset:2048
    v_cvt_pk_bf16_f32 v34, v36, v37
    v_cvt_pk_bf16_f32 v35, v38, v39
    ds_write_b64 v3, v[34:35] offset:2064
    v_cvt_pk_bf16_f32 v36, v40, v41
    v_cvt_pk_bf16_f32 v37, v42, v43
    ds_write_b64 v3, v[36:37] offset:2080
    v_cvt_pk_bf16_f32 v38, v44, v45
    v_cvt_pk_bf16_f32 v39, v46, v47
    ds_write_b64 v3, v[38:39] offset:2096
    v_cvt_pk_bf16_f32 v64, v64, v65
    v_cvt_pk_bf16_f32 v65, v66, v67
    ds_write_b64 v3, v[64:65] offset:2112
    v_cvt_pk_bf16_f32 v66, v68, v69
    v_cvt_pk_bf16_f32 v67, v70, v71
    ds_write_b64 v3, v[66:67] offset:2128
    v_cvt_pk_bf16_f32 v68, v72, v73
    v_cvt_pk_bf16_f32 v69, v74, v75
    ds_write_b64 v3, v[68:69] offset:2144
    v_cvt_pk_bf16_f32 v70, v76, v77
    v_cvt_pk_bf16_f32 v71, v78, v79
    ds_write_b64 v3, v[70:71] offset:2160
    s_waitcnt vmcnt(5) lgkmcnt(0)
    s_barrier
    s_cmp_gt_u32 s48, 1
    s_cbranch_scc1 FQ_2
    ds_read_b64_tr_b16 a[64:65], v5 offset:0
    ds_read_b64_tr_b16 a[96:97], v6 offset:0
    ds_read_b64_tr_b16 a[66:67], v5 offset:544
    ds_read_b64_tr_b16 a[98:99], v6 offset:288
    ds_read_b64_tr_b16 a[68:69], v5 offset:2176
    ds_read_b64_tr_b16 a[100:101], v6 offset:1152
    ds_read_b64_tr_b16 a[70:71], v5 offset:2720
    ds_read_b64_tr_b16 a[102:103], v6 offset:1440
    ds_read_b64_tr_b16 a[72:73], v5 offset:16384
    ds_read_b64_tr_b16 a[104:105], v6 offset:16384
    ds_read_b64_tr_b16 a[74:75], v5 offset:16928
    ds_read_b64_tr_b16 a[106:107], v6 offset:16672
    s_waitcnt lgkmcnt(8)
    v_mfma_f32_32x32x16_bf16 v[32:47], a[64:67], a[96:99], 0
    ds_read_b64_tr_b16 a[76:77], v5 offset:18560
    ds_read_b64_tr_b16 a[108:109], v6 offset:17536
    ds_read_b64_tr_b16 a[78:79], v5 offset:19104
    ds_read_b64_tr_b16 a[110:111], v6 offset:17824
    s_waitcnt lgkmcnt(8)
    v_mfma_f32_32x32x16_bf16 v[32:47], a[68:71], a[100:103], v[32:47]
    ds_read_b64_tr_b16 a[80:81], v5 offset:32768
    ds_read_b64_tr_b16 a[112:113], v6 offset:32768
    ds_read_b64_tr_b16 a[82:83], v5 offset:33312
    ds_read_b64_tr_b16 a[114:115], v6 offset:33056
    s_waitcnt lgkmcnt(8)
    v_mfma_f32_32x32x16_bf16 v[32:47], a[72:75], a[104:107], v[32:47]
    ds_read_b64_tr_b16 a[84:85], v5 offset:34944
    ds_read_b64_tr_b16 a[116:117], v6 offset:33920
    ds_read_b64_tr_b16 a[86:87], v5 offset:35488
    ds_read_b64_tr_b16 a[118:119], v6 offset:34208
    s_waitcnt lgkmcnt(8)
    v_mfma_f32_32x32x16_bf16 v[32:47], a[76:79], a[108:111], v[32:47]
    ds_read_b64_tr_b16 a[88:89], v5 offset:49152
    ds_read_b64_tr_b16 a[120:121], v6 offset:49152
    ds_read_b64_tr_b16 a[90:91], v5 offset:49696
    ds_read_b64_tr_b16 a[122:123], v6 offset:49440
    s_waitcnt lgkmcnt(8)
    v_mfma_f32_32x32x16_bf16 v[32:47], a[80:83], a[112:115], v[32:47]
    ds_read_b64_tr_b16 a[92:93], v5 offset:51328
    ds_read_b64_tr_b16 a[124:125], v6 offset:50304
    ds_read_b64_tr_b16 a[94:95], v5 offset:51872
    ds_read_b64_tr_b16 a[126:127], v6 offset:50592
    s_lshl_b32 s74, s52, 16
    s_lshl_b32 s72, s51, 10
    s_add_u32 s72, s72, s74
    s_add_u32 s73, s72, 16384
    s_lshr_b32 s75, s51, 2
    s_lshl_b32 s75, s75, 10
    s_waitcnt lgkmcnt(8)
    v_mfma_f32_32x32x16_bf16 v[32:47], a[84:87], a[116:119], v[32:47]
    s_add_u32 s74, s74, s75
    s_add_u32 s74, s74, 32768
    s_and_b32 s75, s51, 3
    s_lshl_b32 s75, s75, 8
    v_lshl_add_u32 v29, v1, 2, s75
    v_mov_b32 v28, v29
    s_waitcnt lgkmcnt(4)
    v_mfma_f32_32x32x16_bf16 v[32:47], a[88:91], a[120:123], v[32:47]
    v_mov_b32 v29, v2
    s_cmp_eq_u32 s48, 0
    s_cselect_b32 s76, 0x0000ffff, s63
    s_cselect_b32 s77, 0x00010000, 1
    s_waitcnt lgkmcnt(0)
    v_mfma_f32_32x32x16_bf16 v[32:47], a[92:95], a[124:127], v[32:47]
    s_mov_b32 exec_lo, s76
    s_mov_b32 exec_hi, s76
    s_nop 9
    v_cvt_pk_bf16_f32 v80, v32, v33
    v_cvt_pk_bf16_f32 v81, v34, v35
    v_cvt_pk_bf16_f32 v82, v36, v37
    v_cvt_pk_bf16_f32 v83, v38, v39
    buffer_store_dwordx4 v[80:83], v29, s[40:43], s72 offen sc1
    v_cvt_pk_bf16_f32 v84, v40, v41
    v_cvt_pk_bf16_f32 v85, v42, v43
    v_cvt_pk_bf16_f32 v86, v44, v45
    v_cvt_pk_bf16_f32 v87, v46, v47
    buffer_store_dwordx4 v[84:87], v29, s[40:43], s73 offen sc1
    s_mov_b32 exec_lo, s77
    s_mov_b32 exec_hi, s77
    buffer_store_dwordx4 v[32:35], v28, s[40:43], s74 offen offset:0 sc1
    buffer_store_dwordx4 v[36:39], v28, s[40:43], s74 offen offset:16 sc1
    buffer_store_dwordx4 v[40:43], v28, s[40:43], s74 offen offset:32 sc1
    buffer_store_dwordx4 v[44:47], v28, s[40:43], s74 offen offset:48 sc1
    s_mov_b64 exec, -1
    s_branch FE_1
FQ_2:
    ds_read_b64_tr_b16 v[64:65], v54 offset:0
    ds_read_b64_tr_b16 v[66:67], v54 offset:256
    ds_read_b64_tr_b16 v[68:69], v54 offset:1024
    ds_read_b64_tr_b16 v[70:71], v54 offset:1280
    ds_read_b64_tr_b16 v[72:73], v54 offset:4096
    ds_read_b64_tr_b16 v[74:75], v54 offset:4352
    ds_read_b64_tr_b16 v[76:77], v54 offset:5120
    ds_read_b64_tr_b16 v[78:79], v54 offset:5376
    ds_read_b64_tr_b16 v[80:81], v54 offset:8192
    ds_read_b64_tr_b16 v[82:83], v54 offset:8448
    ds_read_b64_tr_b16 v[84:85], v54 offset:9216
    ds_read_b64_tr_b16 v[86:87], v54 offset:9472
    v_mov_b32 v20, 0
    v_mov_b32 v21, 0
    s_waitcnt lgkmcnt(10)
    v_dot2c_f32_bf16 v20, s62, v64
    v_dot2c_f32_bf16 v21, s62, v65
    v_dot2c_f32_bf16 v20, s62, v66
    v_dot2c_f32_bf16 v21, s62, v67
    ds_read_b64_tr_b16 v[88:89], v54 offset:12288
    ds_read_b64_tr_b16 v[90:91], v54 offset:12544
    s_waitcnt lgkmcnt(10)
    v_dot2c_f32_bf16 v20, s62, v68
    v_dot2c_f32_bf16 v21, s62, v69
    v_dot2c_f32_bf16 v20, s62, v70
    v_dot2c_f32_bf16 v21, s62, v71
    ds_read_b64_tr_b16 v[92:93], v54 offset:13312
    ds_read_b64_tr_b16 v[94:95], v54 offset:13568
    s_waitcnt lgkmcnt(10)
    v_dot2c_f32_bf16 v20, s62, v72
    v_dot2c_f32_bf16 v21, s62, v73
    v_dot2c_f32_bf16 v20, s62, v74
    v_dot2c_f32_bf16 v21, s62, v75
    ds_read_b64_tr_b16 v[64:65], v54 offset:16384
    ds_read_b64_tr_b16 v[66:67], v54 offset:16640
    s_waitcnt lgkmcnt(10)
    v_dot2c_f32_bf16 v20, s62, v76
    v_dot2c_f32_bf16 v21, s62, v77
    v_dot2c_f32_bf16 v20, s62, v78
    v_dot2c_f32_bf16 v21, s62, v79
    ds_read_b64_tr_b16 v[68:69], v54 offset:17408
    ds_read_b64_tr_b16 v[70:71], v54 offset:17664
    s_waitcnt lgkmcnt(10)
    v_dot2c_f32_bf16 v20, s62, v80
    v_dot2c_f32_bf16 v21, s62, v81
    v_dot2c_f32_bf16 v20, s62, v82
    v_dot2c_f32_bf16 v21, s62, v83
    ds_read_b64_tr_b16 v[72:73], v54 offset:20480
    ds_read_b64_tr_b16 v[74:75], v54 offset:20736
    s_waitcnt lgkmcnt(10)
    v_dot2c_f32_bf16 v20, s62, v84
    v_dot2c_f32_bf16 v21, s62, v85
    v_dot2c_f32_bf16 v20, s62, v86
    v_dot2c_f32_bf16 v21, s62, v87
    ds_read_b64_tr_b16 v[76:77], v54 offset:21504
    ds_read_b64_tr_b16 v[78:79], v54 offset:21760
    s_waitcnt lgkmcnt(10)
    v_dot2c_f32_bf16 v20, s62, v88
    v_dot2c_f32_bf16 v21, s62, v89
    v_dot2c_f32_bf16 v20, s62, v90
    v_dot2c_f32_bf16 v21, s62, v91
    ds_read_b64_tr_b16 v[80:81], v54 offset:24576
    ds_read_b64_tr_b16 v[82:83], v54 offset:24832
    s_waitcnt lgkmcnt(10)
    v_dot2c_f32_bf16 v20, s62, v92
    v_dot2c_f32_bf16 v21, s62, v93
    v_dot2c_f32_bf16 v20, s62, v94
    v_dot2c_f32_bf16 v21, s62, v95
    ds_read_b64_tr_b16 v[84:85], v54 offset:25600
    ds_read_b64_tr_b16 v[86:87], v54 offset:25856
    s_waitcnt lgkmcnt(10)
    v_dot2c_f32_bf16 v20, s62, v64
    v_dot2c_f32_bf16 v21, s62, v65
    v_dot2c_f32_bf16 v20, s62, v66
    v_dot2c_f32_bf16 v21, s62, v67
    ds_read_b64_tr_b16 v[88:89], v54 offset:28672
    ds_read_b64_tr_b16 v[90:91], v54 offset:28928
    s_waitcnt lgkmcnt(10)
    v_dot2c_f32_bf16 v20, s62, v68
    v_dot2c_f32_bf16 v21, s62, v69
    v_dot2c_f32_bf16 v20, s62, v70
    v_dot2c_f32_bf16 v21, s62, v71
    ds_read_b64_tr_b16 v[92:93], v54 offset:29696
    ds_read_b64_tr_b16 v[94:95], v54 offset:29952
    s_waitcnt lgkmcnt(10)
    v_dot2c_f32_bf16 v20, s62, v72
    v_dot2c_f32_bf16 v21, s62, v73
    v_dot2c_f32_bf16 v20, s62, v74
    v_dot2c_f32_bf16 v21, s62, v75
    s_waitcnt lgkmcnt(8)
    v_dot2c_f32_bf16 v20, s62, v76
    v_dot2c_f32_bf16 v21, s62, v77
    v_dot2c_f32_bf16 v20, s62, v78
    v_dot2c_f32_bf16 v21, s62, v79
    s_waitcnt lgkmcnt(6)
    v_dot2c_f32_bf16 v20, s62, v80
    v_dot2c_f32_bf16 v21, s62, v81
    v_dot2c_f32_bf16 v20, s62, v82
    v_dot2c_f32_bf16 v21, s62, v83
    s_waitcnt lgkmcnt(4)
    v_dot2c_f32_bf16 v20, s62, v84
    v_dot2c_f32_bf16 v21, s62, v85
    v_dot2c_f32_bf16 v20, s62, v86
    v_dot2c_f32_bf16 v21, s62, v87
    s_waitcnt lgkmcnt(2)
    v_dot2c_f32_bf16 v20, s62, v88
    v_dot2c_f32_bf16 v21, s62, v89
    v_dot2c_f32_bf16 v20, s62, v90
    v_dot2c_f32_bf16 v21, s62, v91
    s_waitcnt lgkmcnt(0)
    v_dot2c_f32_bf16 v20, s62, v92
    v_dot2c_f32_bf16 v21, s62, v93
    v_dot2c_f32_bf16 v20, s62, v94
    v_dot2c_f32_bf16 v21, s62, v95
    v_and_b32 v22, 31, v1
    v_lshlrev_b32 v22, 3, v22
    s_lshl_b32 s72, s48, 2
    s_add_u32 s72, s72, 66552
    v_add_f32 v20, v20, v21
    v_mov_b32 v21, v20
    v_add_u32 v28, s72, v22
    s_nop 0
    v_permlane32_swap_b32 v20, v21
    v_add_f32 v20, v20, v21
    ds_write_b32 v28, v20
FE_1:
    ds_read_b64_tr_b16 a[128:129], v50 offset:0
    ds_read_b64_tr_b16 a[130:131], v50 offset:256
    ds_read_b64_tr_b16 a[132:133], v51 offset:0
    ds_read_b64_tr_b16 a[134:135], v51 offset:256
    ds_read_b64_tr_b16 a[136:137], v52 offset:0
    ds_read_b64_tr_b16 a[138:139], v52 offset:256
    ds_read_b64_tr_b16 a[140:141], v53 offset:0
    ds_read_b64_tr_b16 a[142:143], v53 offset:256
    ds_read_b64_tr_b16 a[144:145], v50 offset:4096
    ds_read_b64_tr_b16 a[146:147], v50 offset:4352
    s_waitcnt lgkmcnt(8)
    v_mfma_f32_32x32x16_bf16 v[96:111], a[128:131], v[128:131], 0
    ds_read_b64_tr_b16 a[148:149], v51 offset:4096
    ds_read_b64_tr_b16 a[150:151], v51 offset:4352
    v_lshrrev_b32 v29, 3, v1
    v_bfe_u32 v30, v1, 4, 1
    v_lshlrev_b32 v30, 2, v30
    s_waitcnt lgkmcnt(8)
    v_mfma_f32_32x32x16_bf16 v[96:111], a[132:135], v[132:135], v[96:111]
    ds_read_b64_tr_b16 a[152:153], v52 offset:4096
    ds_read_b64_tr_b16 a[154:155], v52 offset:4352
    v_and_b32 v31, 7, v1
    v_xor_b32 v30, v30, v31
    v_lshlrev_b32 v30, 4, v30
    s_add_u32 m0, s78, 0
    s_add_u32 s79, s71, 0
    buffer_load_dwordx4 v48, s[24:27], s79 offen lds
    s_waitcnt lgkmcnt(8)
    v_mfma_f32_32x32x16_bf16 v[96:111], a[136:139], v[136:139], v[96:111]
    ds_read_b64_tr_b16 a[156:157], v53 offset:4096
    ds_read_b64_tr_b16 a[158:159], v53 offset:4352
    v_lshl_add_u32 v3, v29, 10, v30
    v_add_u32 v4, 7168, v3
    v_bfe_u32 v29, v1, 2, 2
    s_waitcnt lgkmcnt(8)
    v_mfma_f32_32x32x16_bf16 v[96:111], a[140:143], v[140:143], v[96:111]
    ds_read_b64_tr_b16 a[128:129], v50 offset:8192
    ds_read_b64_tr_b16 a[130:131], v50 offset:8448
    v_lshl_add_u32 v30, v25, 2, v29
    v_lshlrev_b32 v30, 7, v30
    v_bfe_u32 v31, v1, 4, 1
    s_waitcnt lgkmcnt(8)
    v_mfma_f32_32x32x16_bf16 v[96:111], a[144:147], v[144:147], v[96:111]
    ds_read_b64_tr_b16 a[132:133], v51 offset:8192
    ds_read_b64_tr_b16 a[134:135], v51 offset:8448
    v_lshl_add_u32 v30, v31, 5, v30
    v_and_b32 v31, 3, v1
    v_lshl_add_u32 v30, v31, 3, v30
    s_add_u32 m0, s78, 1024
    s_add_u32 s79, s71, 28672
    buffer_load_dwordx4 v48, s[24:27], s79 offen lds
    s_waitcnt lgkmcnt(8)
    v_mfma_f32_32x32x16_bf16 v[96:111], a[148:151], v[148:151], v[96:111]
    ds_read_b64_tr_b16 a[136:137], v52 offset:8192
    ds_read_b64_tr_b16 a[138:139], v52 offset:8448
    v_bfe_u32 v31, v1, 3, 1
    s_and_b32 s72, s48, 1
    v_xor_b32 v31, s72, v31
    s_waitcnt lgkmcnt(8)
    v_mfma_f32_32x32x16_bf16 v[96:111], a[152:155], v[152:155], v[96:111]
    ds_read_b64_tr_b16 a[140:141], v53 offset:8192
    ds_read_b64_tr_b16 a[142:143], v53 offset:8448
    v_lshl_add_u32 v30, v31, 6, v30
    s_lshl_b32 s72, s72, 15
    s_add_u32 s72, s72, 65536
    s_waitcnt lgkmcnt(8)
    v_mfma_f32_32x32x16_bf16 v[96:111], a[156:159], v[156:159], v[96:111]
    ds_read_b64_tr_b16 a[144:145], v50 offset:12288
    ds_read_b64_tr_b16 a[146:147], v50 offset:12544
    v_add_u32 v7, s72, v30
    v_xor_b32 v8, 64, v7
    s_mul_i32 s98, s48, 6144
    s_add_u32 m0, s78, 2048
    s_add_u32 s79, s71, 57344
    buffer_load_dwordx4 v48, s[24:27], s79 offen lds
    s_waitcnt lgkmcnt(8)
    v_mfma_f32_32x32x16_bf16 v[96:111], a[128:131], v[160:163], v[96:111]
    ds_read_b64_tr_b16 a[148:149], v51 offset:12288
    ds_read_b64_tr_b16 a[150:151], v51 offset:12544
    v_add_u32 v5, s98, v30
    v_add_u32 v5, 139264, v5
    v_xor_b32 v6, 64, v5
    s_waitcnt lgkmcnt(8)
    v_mfma_f32_32x32x16_bf16 v[96:111], a[132:135], v[164:167], v[96:111]
    ds_read_b64_tr_b16 a[152:153], v52 offset:12288
    ds_read_b64_tr_b16 a[154:155], v52 offset:12544
    v_and_b32 v29, 31, v1
    v_lshlrev_b32 v17, 10, v29
    v_lshrrev_b32 v10, 2, v1
    s_waitcnt lgkmcnt(8)
    v_mfma_f32_32x32x16_bf16 v[96:111], a[136:139], v[168:171], v[96:111]
    ds_read_b64_tr_b16 a[156:157], v53 offset:12288
    ds_read_b64_tr_b16 a[158:159], v53 offset:12544
    v_lshlrev_b32 v10, 10, v10
    v_bfe_u32 v30, v1, 3, 2
    v_xor_b32 v30, v30, v1
    s_add_u32 m0, s78, 3072
    s_add_u32 s79, s71, 86016
    buffer_load_dwordx4 v48, s[24:27], s79 offen lds
    s_waitcnt lgkmcnt(8)
    v_mfma_f32_32x32x16_bf16 v[96:111], a[140:143], v[172:175], v[96:111]
    ds_read_b64_tr_b16 a[128:129], v50 offset:16384
    ds_read_b64_tr_b16 a[130:131], v50 offset:16640
    v_and_b32 v30, 3, v30
    v_lshl_add_u32 v10, v30, 4, v10
    v_lshlrev_b32 v22, 3, v29
    s_waitcnt lgkmcnt(8)
    v_mfma_f32_32x32x16_bf16 v[96:111], a[144:147], v[176:179], v[96:111]
    ds_read_b64_tr_b16 a[132:133], v51 offset:16384
    ds_read_b64_tr_b16 a[134:135], v51 offset:16640
    v_add_u32 v22, 66560, v22
    s_lshl_b32 s72, s49, 3
    s_lshl_b32 s73, s56, 1
    s_waitcnt lgkmcnt(8)
    v_mfma_f32_32x32x16_bf16 v[96:111], a[148:151], v[180:183], v[96:111]
    ds_read_b64_tr_b16 a[136:137], v52 offset:16384
    ds_read_b64_tr_b16 a[138:139], v52 offset:16640
    s_add_u32 s72, s72, s73
    s_lshr_b32 s73, s48, 1
    s_add_u32 s87, s72, s73
    s_add_u32 m0, s78, 16384
    s_add_u32 s79, s71, 0
    buffer_load_dwordx4 v49, s[28:31], s79 offen lds
    s_waitcnt lgkmcnt(8)
    v_mfma_f32_32x32x16_bf16 v[96:111], a[152:155], v[184:187], v[96:111]
    ds_read_b64_tr_b16 a[140:141], v53 offset:16384
    ds_read_b64_tr_b16 a[142:143], v53 offset:16640
    s_lshl_b32 s72, s87, 15
    s_lshl_b32 s73, s57, 7
    s_add_u32 s72, s72, s73
    s_waitcnt lgkmcnt(8)
    v_mfma_f32_32x32x16_bf16 v[96:111], a[156:159], v[188:191], v[96:111]
    ds_read_b64_tr_b16 a[144:145], v50 offset:20480
    ds_read_b64_tr_b16 a[146:147], v50 offset:20736
    s_and_b32 s73, s48, 1
    s_lshl_b32 s73, s73, 6
    s_add_u32 s86, s72, s73
    s_waitcnt lgkmcnt(8)
    v_mfma_f32_32x32x16_bf16 v[96:111], a[128:131], v[192:195], v[96:111]
    ds_read_b64_tr_b16 a[148:149], v51 offset:20480
    ds_read_b64_tr_b16 a[150:151], v51 offset:20736
    s_lshl_b32 s72, s52, 12
    s_add_u32 s72, s72, 25165824
    s_lshl_b32 s73, s49, 12
    s_add_u32 m0, s78, 17408
    s_add_u32 s79, s71, 28672
    buffer_load_dwordx4 v49, s[28:31], s79 offen lds
    s_waitcnt lgkmcnt(8)
    v_mfma_f32_32x32x16_bf16 v[96:111], a[132:135], v[196:199], v[96:111]
    ds_read_b64_tr_b16 a[152:153], v52 offset:20480
    ds_read_b64_tr_b16 a[154:155], v52 offset:20736
    s_add_u32 s73, s73, 25423872
    v_mov_b32 v14, s72
    v_mov_b32 v15, s73
    s_waitcnt lgkmcnt(8)
    v_mfma_f32_32x32x16_bf16 v[96:111], a[136:139], v[200:203], v[96:111]
    ds_read_b64_tr_b16 a[156:157], v53 offset:20480
    ds_read_b64_tr_b16 a[158:159], v53 offset:20736
    v_cndmask_b32 v13, v14, v15, s[60:61]
    v_lshl_add_u32 v13, v1, 7, v13
    s_lshl_b32 s74, s48, 17
    s_lshl_b32 s75, s57, 7
    s_add_u32 s74, s74, s75
    s_lshl_b32 s81, s52, 16
    s_and_b32 s72, s48, 1
    s_lshl_b32 s72, s72, 14
    s_add_u32 s80, s72, s81
    s_lshr_b32 s73, s48, 1
    s_lshl_b32 s73, s73, 13
    s_add_u32 s80, s80, s73
    s_add_u32 s81, s81, 32768
    v_mov_b32 v11, v2
    s_cmp_lg_u32 s54, 0
    s_cbranch_scc1 TG_4
    s_mov_b32 s73, 0
TG_5:
    buffer_load_dwordx2 v[30:31], off, s[44:47], 0 sc1
    s_add_u32 s73, s73, 1
    s_waitcnt vmcnt(0)
    v_readfirstlane_b32 s54, v30
    v_readfirstlane_b32 s55, v31
    s_cmp_gt_u32 s73, 0x400000
    s_cbranch_scc1 TG_4
    s_cmp_eq_u32 s54, 0
    s_cbranch_scc1 TG_5
TG_4:
    s_cmp_gt_u32 s48, 1
    s_cbranch_scc1 FLG_3
    s_lshl_b32 s72, s52, 5
    s_lshl_b32 s73, s51, 1
    s_add_u32 s72, s72, s73
    s_add_u32 s72, s72, s48
    s_lshl_b32 s72, s72, 7
    s_add_u32 s72, s72, 25165824
    v_mov_b32 v30, s54
    v_mov_b32 v31, s55
    s_mov_b64 exec, 1
    s_waitcnt vmcnt(6)
    buffer_store_dwordx2 v[30:31], off, s[40:43], s72 sc1
    s_cmp_lg_u32 s48, 0
    s_cbranch_scc1 XI_6
    s_lshl_b32 s72, s49, 5
    s_add_u32 s72, s72, s50
    s_lshl_b32 s72, s72, 7
    s_add_u32 s72, s72, 25427968
    s_lshl_b32 s73, s96, 28
    s_or_b32 s73, s73, s55
    v_mov_b32 v28, s54
    v_mov_b32 v29, s73
    buffer_store_dwordx2 v[28:29], off, s[40:43], s72 sc1
XI_6:
    s_mov_b64 exec, -1
FLG_3:
    s_cmp_lt_u32 s48, 2
    s_cbranch_scc1 TE_7
    v_lshlrev_b32 v31, 7, v1
    s_lshl_b32 s77, s2, 1
    s_add_u32 s77, s77, s48
    s_sub_u32 s77, s77, 2
    s_sub_u32 s72, s77, 64
    s_cmp_lt_u32 s72, 32
    s_cbranch_scc0 TN_8
    s_lshr_b32 s72, s72, 4
    s_lshl_b32 s72, s72, 1
    s_add_u32 s72, s72, s48
    s_sub_u32 s72, s72, 2
    s_lshl_b32 s73, s49, 2
    s_add_u32 s72, s72, s73
    s_lshl_b32 s72, s72, 13
    s_add_u32 s72, s72, 5242880
    buffer_load_dword a200, v31, s[40:43], s72 offen
TN_8:
TE_7:
    s_waitcnt lgkmcnt(8)
    v_mfma_f32_32x32x16_bf16 v[96:111], a[140:143], v[204:207], v[96:111]
    ds_read_b64_tr_b16 a[128:129], v50 offset:24576
    ds_read_b64_tr_b16 a[130:131], v50 offset:24832
    s_add_u32 m0, s78, 18432
    s_add_u32 s79, s71, 57344
    buffer_load_dwordx4 v49, s[28:31], s79 offen lds
    s_waitcnt lgkmcnt(8)
    v_mfma_f32_32x32x16_bf16 v[96:111], a[144:147], v[208:211], v[96:111]
    ds_read_b64_tr_b16 a[132:133], v51 offset:24576
    ds_read_b64_tr_b16 a[134:135], v51 offset:24832
    s_waitcnt lgkmcnt(8)
    v_mfma_f32_32x32x16_bf16 v[96:111], a[148:151], v[212:215], v[96:111]
    ds_read_b64_tr_b16 a[136:137], v52 offset:24576
    ds_read_b64_tr_b16 a[138:139], v52 offset:24832
    s_waitcnt lgkmcnt(8)
    v_mfma_f32_32x32x16_bf16 v[96:111], a[152:155], v[216:219], v[96:111]
    ds_read_b64_tr_b16 a[140:141], v53 offset:24576
    ds_read_b64_tr_b16 a[142:143], v53 offset:24832
    s_add_u32 m0, s78, 19456
    s_add_u32 s79, s71, 86016
    buffer_load_dwordx4 v49, s[28:31], s79 offen lds
    s_waitcnt lgkmcnt(8)
    v_mfma_f32_32x32x16_bf16 v[96:111], a[156:159], v[220:223], v[96:111]
    ds_read_b64_tr_b16 a[144:145], v50 offset:28672
    ds_read_b64_tr_b16 a[146:147], v50 offset:28928
    s_waitcnt lgkmcnt(8)
    v_mfma_f32_32x32x16_bf16 v[96:111], a[128:131], v[224:227], v[96:111]
    ds_read_b64_tr_b16 a[148:149], v51 offset:28672
    ds_read_b64_tr_b16 a[150:151], v51 offset:28928
    s_waitcnt lgkmcnt(8)
    v_mfma_f32_32x32x16_bf16 v[96:111], a[132:135], v[228:231], v[96:111]
    ds_read_b64_tr_b16 a[152:153], v52 offset:28672
    ds_read_b64_tr_b16 a[154:155], v52 offset:28928
    s_waitcnt lgkmcnt(8)
    v_mfma_f32_32x32x16_bf16 v[96:111], a[136:139], v[232:235], v[96:111]
    ds_read_b64_tr_b16 a[156:157], v53 offset:28672
    ds_read_b64_tr_b16 a[158:159], v53 offset:28928
    s_waitcnt lgkmcnt(8)
    v_mfma_f32_32x32x16_bf16 v[96:111], a[140:143], v[236:239], v[96:111]
    s_waitcnt lgkmcnt(0)
    s_barrier
    ds_read_b64 v[64:65], v22
    v_mfma_f32_32x32x16_bf16 v[96:111], a[144:147], v[240:243], v[96:111]
    s_add_u32 m0, s66, 2048
    s_add_u32 s76, s74, 16384
    buffer_load_dwordx4 v3, s[20:23], s76 offen lds
    buffer_load_dwordx4 v4, s[20:23], s76 offen offset:1024 lds
    v_mfma_f32_32x32x16_bf16 v[96:111], a[148:151], v[244:247], v[96:111]
    s_waitcnt lgkmcnt(0)
    v_add_f32 v64, v64, v65
    v_cvt_pk_bf16_f32 v125, v64, 0
    v_lshlrev_b32 v31, 16, v125
    v_sub_f32 v31, v64, v31
    v_cvt_pk_bf16_f32 v124, v64, v31
    v_mfma_f32_32x32x16_bf16 v[96:111], a[152:155], v[248:251], v[96:111]
    s_add_u32 m0, s66, 4096
    s_add_u32 s76, s74, 32768
    buffer_load_dwordx4 v3, s[20:23], s76 offen lds
    buffer_load_dwordx4 v4, s[20:23], s76 offen offset:1024 lds
    v_mfma_f32_32x32x16_bf16 v[96:111], a[156:159], v[252:255], v[96:111]
    v_mfma_f32_32x32x16_bf16 v[96:111], v[124:127], v[120:123], v[96:111]
    s_add_u32 m0, s66, 6144
    s_add_u32 s76, s74, 49152
    buffer_load_dwordx4 v3, s[20:23], s76 offen lds
    buffer_load_dwordx4 v4, s[20:23], s76 offen offset:1024 lds
    s_nop 7
    v_cvt_pk_bf16_f32 v56, v96, v97
    v_cvt_pk_bf16_f32 v57, v98, v99
    v_cvt_pk_bf16_f32 v58, v100, v101
    v_cvt_pk_bf16_f32 v59, v102, v103
    v_cvt_pk_bf16_f32 v60, v104, v105
    v_cvt_pk_bf16_f32 v61, v106, v107
    v_cvt_pk_bf16_f32 v62, v108, v109
    v_cvt_pk_bf16_f32 v63, v110, v111
    v_mfma_f32_32x32x16_bf16 v[32:47], v[112:115], v[56:59], 0
    s_nop 0
    v_mfma_f32_32x32x16_bf16 v[64:79], v[116:119], v[60:63], 0
    s_nop 9
    v_max3_f32 v96, v32, v33, v34
    s_add_u32 m0, s66, 8192
    v_max3_f32 v97, v40, v41, v42
    v_max3_f32 v98, v64, v65, v66
    v_max3_f32 v99, v72, v73, v74
    v_max3_f32 v96, v96, v35, v36
    s_add_u32 s76, s74, 65536
    v_max3_f32 v97, v97, v43, v44
    v_max3_f32 v98, v98, v67, v68
    v_max3_f32 v99, v99, v75, v76
    v_max3_f32 v96, v96, v37, v38
    v_max3_f32 v97, v97, v45, v46
    buffer_load_dwordx4 v3, s[20:23], s76 offen lds
    v_max3_f32 v98, v98, v69, v70
    v_max3_f32 v99, v99, v77, v78
    v_max_f32 v96, v96, v39
    v_max_f32 v97, v97, v47
    buffer_load_dwordx4 v4, s[20:23], s76 offen offset:1024 lds
    v_max_f32 v98, v98, v71
    v_max_f32 v99, v99, v79
    v_permlane32_swap_b32 v96, v97
    s_nop 0
    v_permlane32_swap_b32 v98, v99
    v_max_f32 v96, v96, v97
    s_add_u32 m0, s66, 10240
    v_max_f32 v98, v98, v99
    v_mov_b32 v97, v96
    v_mov_b32 v99, v98
    s_nop 0
    s_add_u32 s76, s74, 81920
    v_permlane32_swap_b32 v96, v97
    v_permlane32_swap_b32 v98, v99
    v_mul_f32 v100, -v96, v26
    v_mul_f32 v102, -v97, v26
    v_mul_f32 v104, -v98, v26
    buffer_load_dwordx4 v3, s[20:23], s76 offen lds
    v_mul_f32 v106, -v99, v26
    v_pk_fma_f32 v[32:33], v[32:33], v[26:27], v[100:101] op_sel_hi:[1,0,0]
    v_pk_fma_f32 v[34:35], v[34:35], v[26:27], v[100:101] op_sel_hi:[1,0,0]
    v_pk_fma_f32 v[36:37], v[36:37], v[26:27], v[100:101] op_sel_hi:[1,0,0]
    buffer_load_dwordx4 v4, s[20:23], s76 offen offset:1024 lds
    v_pk_fma_f32 v[38:39], v[38:39], v[26:27], v[100:101] op_sel_hi:[1,0,0]
    v_pk_fma_f32 v[40:41], v[40:41], v[26:27], v[102:103] op_sel_hi:[1,0,0]
    v_pk_fma_f32 v[42:43], v[42:43], v[26:27], v[102:103] op_sel_hi:[1,0,0]
    v_pk_fma_f32 v[44:45], v[44:45], v[26:27], v[102:103] op_sel_hi:[1,0,0]
    v_pk_fma_f32 v[46:47], v[46:47], v[26:27], v[102:103] op_sel_hi:[1,0,0]
    s_add_u32 m0, s66, 12288
    v_pk_fma_f32 v[64:65], v[64:65], v[26:27], v[104:105] op_sel_hi:[1,0,0]
    v_pk_fma_f32 v[66:67], v[66:67], v[26:27], v[104:105] op_sel_hi:[1,0,0]
    v_pk_fma_f32 v[68:69], v[68:69], v[26:27], v[104:105] op_sel_hi:[1,0,0]
    v_pk_fma_f32 v[70:71], v[70:71], v[26:27], v[104:105] op_sel_hi:[1,0,0]
    s_add_u32 s76, s74, 98304
    v_pk_fma_f32 v[72:73], v[72:73], v[26:27], v[106:107] op_sel_hi:[1,0,0]
    v_pk_fma_f32 v[74:75], v[74:75], v[26:27], v[106:107] op_sel_hi:[1,0,0]
    v_pk_fma_f32 v[76:77], v[76:77], v[26:27], v[106:107] op_sel_hi:[1,0,0]
    v_pk_fma_f32 v[78:79], v[78:79], v[26:27], v[106:107] op_sel_hi:[1,0,0]
    v_exp_f32 v32, v32
    buffer_load_dwordx4 v3, s[20:23], s76 offen lds
    v_exp_f32 v33, v33
    v_exp_f32 v34, v34
    v_exp_f32 v35, v35
    v_exp_f32 v36, v36
    v_exp_f32 v37, v37
    buffer_load_dwordx4 v4, s[20:23], s76 offen offset:1024 lds
    v_exp_f32 v38, v38
    v_exp_f32 v39, v39
    v_exp_f32 v40, v40
    v_exp_f32 v41, v41
    s_add_u32 m0, s66, 14336
    v_exp_f32 v42, v42
    v_exp_f32 v43, v43
    v_exp_f32 v44, v44
    v_exp_f32 v45, v45
    v_exp_f32 v46, v46
    s_add_u32 s76, s74, 114688
    v_exp_f32 v47, v47
    v_exp_f32 v64, v64
    v_exp_f32 v65, v65
    v_exp_f32 v66, v66
    buffer_load_dwordx4 v3, s[20:23], s76 offen lds
    v_exp_f32 v67, v67
    v_exp_f32 v68, v68
    v_exp_f32 v69, v69
    v_exp_f32 v70, v70
    v_exp_f32 v71, v71
    buffer_load_dwordx4 v4, s[20:23], s76 offen offset:1024 lds
    v_exp_f32 v72, v72
    v_exp_f32 v73, v73
    v_exp_f32 v74, v74
    v_exp_f32 v75, v75
    s_lshl_b32 s76, s48, 11
    v_exp_f32 v76, v76
    v_exp_f32 v77, v77
    v_exp_f32 v78, v78
    v_exp_f32 v79, v79
    v_pk_add_f32 v[100:101], v[32:33], v[34:35]
    s_add_u32 m0, s76, 141312
    v_pk_add_f32 v[102:103], v[40:41], v[42:43]
    v_pk_add_f32 v[104:105], v[64:65], v[66:67]
    v_pk_add_f32 v[106:107], v[72:73], v[74:75]
    v_pk_add_f32 v[100:101], v[100:101], v[36:37]
    buffer_load_dwordx4 v10, s[8:11], s86 offen lds
    v_pk_add_f32 v[102:103], v[102:103], v[44:45]
    v_pk_add_f32 v[104:105], v[104:105], v[68:69]
    v_pk_add_f32 v[106:107], v[106:107], v[76:77]
    v_pk_add_f32 v[100:101], v[100:101], v[38:39]
    v_pk_add_f32 v[102:103], v[102:103], v[46:47]
    s_add_u32 m0, s76, 142336
    v_pk_add_f32 v[104:105], v[104:105], v[70:71]
    v_pk_add_f32 v[106:107], v[106:107], v[78:79]
    v_add_f32 v96, v100, v101
    v_add_f32 v97, v102, v103
    s_add_u32 s76, s86, 16384
    v_add_f32 v98, v104, v105
    v_add_f32 v99, v106, v107
    v_permlane32_swap_b32 v96, v97
    s_nop 0
    v_permlane32_swap_b32 v98, v99
    v_add_f32 v96, v96, v97
    buffer_load_dwordx4 v10, s[8:11], s76 offen lds
    v_add_f32 v98, v98, v99
    v_mov_b32 v97, v96
    v_mov_b32 v99, v98
    s_nop 0
    s_cmp_lg_u32 s48, 0
    s_cbranch_scc1 PRB_9
    buffer_load_dwordx2 v[14:15], v13, s[40:43], 0 offen sc1
PRB_9:
    v_permlane32_swap_b32 v96, v97
    v_permlane32_swap_b32 v98, v99
    v_rcp_f32 v100, v96
    v_rcp_f32 v102, v97
    v_rcp_f32 v104, v98
    v_rcp_f32 v106, v99
    v_pk_mul_f32 v[32:33], v[32:33], v[100:101] op_sel_hi:[1,0]
    v_pk_mul_f32 v[34:35], v[34:35], v[100:101] op_sel_hi:[1,0]
    v_pk_mul_f32 v[36:37], v[36:37], v[100:101] op_sel_hi:[1,0]
    v_pk_mul_f32 v[38:39], v[38:39], v[100:101] op_sel_hi:[1,0]
    v_pk_mul_f32 v[40:41], v[40:41], v[102:103] op_sel_hi:[1,0]
    v_pk_mul_f32 v[42:43], v[42:43], v[102:103] op_sel_hi:[1,0]
    v_pk_mul_f32 v[44:45], v[44:45], v[102:103] op_sel_hi:[1,0]
    v_pk_mul_f32 v[46:47], v[46:47], v[102:103] op_sel_hi:[1,0]
    v_pk_mul_f32 v[64:65], v[64:65], v[104:105] op_sel_hi:[1,0]
    v_pk_mul_f32 v[66:67], v[66:67], v[104:105] op_sel_hi:[1,0]
    v_pk_mul_f32 v[68:69], v[68:69], v[104:105] op_sel_hi:[1,0]
    v_pk_mul_f32 v[70:71], v[70:71], v[104:105] op_sel_hi:[1,0]
    v_pk_mul_f32 v[72:73], v[72:73], v[106:107] op_sel_hi:[1,0]
    v_pk_mul_f32 v[74:75], v[74:75], v[106:107] op_sel_hi:[1,0]
    v_pk_mul_f32 v[76:77], v[76:77], v[106:107] op_sel_hi:[1,0]
    v_pk_mul_f32 v[78:79], v[78:79], v[106:107] op_sel_hi:[1,0]
    v_cvt_pk_bf16_f32 v32, v32, v33
    v_cvt_pk_bf16_f32 v33, v34, v35
    v_cvt_pk_bf16_f32 v34, v36, v37
    v_cvt_pk_bf16_f32 v35, v38, v39
    v_cvt_pk_bf16_f32 v36, v40, v41
    v_cvt_pk_bf16_f32 v37, v42, v43
    v_cvt_pk_bf16_f32 v38, v44, v45
    v_cvt_pk_bf16_f32 v39, v46, v47
    v_cvt_pk_bf16_f32 v64, v64, v65
    v_cvt_pk_bf16_f32 v65, v66, v67
    v_cvt_pk_bf16_f32 v66, v68, v69
    v_cvt_pk_bf16_f32 v67, v70, v71
    v_cvt_pk_bf16_f32 v68, v72, v73
    v_cvt_pk_bf16_f32 v69, v74, v75
    v_cvt_pk_bf16_f32 v70, v76, v77
    v_cvt_pk_bf16_f32 v71, v78, v79
    s_waitcnt vmcnt(0)
    s_cmp_lg_u32 s48, 0
    s_cbranch_scc1 POLLX_11
    s_mov_b32 s73, 0
    s_branch POLL_10_c
POLL_10:
    buffer_load_dwordx2 v[14:15], v13, s[40:43], 0 offen sc1
    s_add_u32 s73, s73, 1
    s_waitcnt vmcnt(0)
POLL_10_c:
    v_lshrrev_b32 v31, 28, v15
    v_and_b32 v15, 0x0fffffff, v15
    v_cmp_ne_u64 vcc, s[54:55], v[14:15]
    s_cmp_gt_u32 s73, 0x400000
    s_cbranch_scc1 POLLX_11_d
    s_cmp_lg_u64 vcc, 0
    s_cbranch_scc1 POLL_10
POLLX_11_d:
    v_cmp_ne_u32 vcc, s96, v31
    s_nop 0
    s_cmp_eq_u32 vcc_hi, 0
    s_cselect_b32 s72, 1, 0
    v_mov_b32 v28, s72
    v_mov_b32 v29, 140288
    ds_write_b32 v29, v28
    s_waitcnt lgkmcnt(0)
POLLX_11:
    s_barrier
    v_mov_b32 v9, 140288
    ds_read_b32 v9, v9
    buffer_load_dwordx4 v[160:163], v11, s[40:43], s81 offen offset:0 sc1
    buffer_load_dwordx4 v[164:167], v11, s[40:43], s81 offen offset:1024 sc1
    buffer_load_dwordx4 v[168:171], v11, s[40:43], s81 offen offset:2048 sc1
    buffer_load_dwordx4 v[172:175], v11, s[40:43], s81 offen offset:3072 sc1
    ds_read_b64_tr_b16 a[8:9], v7 offset:2048
    ds_read_b64_tr_b16 a[10:11], v7 offset:3072
    ds_read_b64_tr_b16 a[12:13], v8 offset:2048
    ds_read_b64_tr_b16 a[14:15], v8 offset:3072
    ds_read_b64_tr_b16 a[16:17], v7 offset:4096
    ds_read_b64_tr_b16 a[18:19], v7 offset:5120
    ds_read_b64_tr_b16 a[20:21], v8 offset:4096
    buffer_load_dwordx4 v[128:131], v11, s[40:43], s80 offen offset:0 sc1
    ds_read_b64_tr_b16 a[22:23], v8 offset:5120
    ds_read_b64_tr_b16 a[24:25], v7 offset:6144
    ds_read_b64_tr_b16 a[26:27], v7 offset:7168
    ds_read_b64_tr_b16 a[28:29], v8 offset:6144
    ds_read_b64_tr_b16 a[30:31], v8 offset:7168
    ds_read_b64_tr_b16 a[32:33], v7 offset:8192
    buffer_load_dwordx4 v[132:135], v11, s[40:43], s80 offen offset:1024 sc1
    ds_read_b64_tr_b16 a[34:35], v7 offset:9216
    ds_read_b64_tr_b16 a[36:37], v8 offset:8192
    ds_read_b64_tr_b16 a[38:39], v8 offset:9216
    ds_read_b64_tr_b16 a[40:41], v7 offset:10240
    ds_read_b64_tr_b16 a[42:43], v7 offset:11264
    ds_read_b64_tr_b16 a[44:45], v8 offset:10240
    buffer_load_dwordx4 v[136:139], v11, s[40:43], s80 offen offset:2048 sc1
    ds_read_b64_tr_b16 a[46:47], v8 offset:11264
    ds_read_b64_tr_b16 a[48:49], v7 offset:12288
    ds_read_b64_tr_b16 a[50:51], v7 offset:13312
    ds_read_b64_tr_b16 a[52:53], v8 offset:12288
    ds_read_b64_tr_b16 a[54:55], v8 offset:13312
    ds_read_b64_tr_b16 a[56:57], v7 offset:14336
    buffer_load_dwordx4 v[140:143], v11, s[40:43], s80 offen offset:3072 sc1
    ds_read_b64_tr_b16 a[58:59], v7 offset:15360
    ds_read_b64_tr_b16 a[60:61], v8 offset:14336
    ds_read_b64_tr_b16 a[62:63], v8 offset:15360
    ds_read_b64_tr_b16 a[72:73], v7 offset:18432
    ds_read_b64_tr_b16 a[74:75], v7 offset:19456
    ds_read_b64_tr_b16 a[76:77], v8 offset:18432
    ds_read_b64_tr_b16 a[78:79], v8 offset:19456
    s_add_u32 s80, s80, 4096
    buffer_load_dwordx4 v[144:147], v11, s[40:43], s80 offen offset:0 sc1
    ds_read_b64_tr_b16 a[80:81], v7 offset:20480
    ds_read_b64_tr_b16 a[82:83], v7 offset:21504
    ds_read_b64_tr_b16 a[84:85], v8 offset:20480
    ds_read_b64_tr_b16 a[86:87], v8 offset:21504
    ds_read_b64_tr_b16 a[88:89], v7 offset:22528
    ds_read_b64_tr_b16 a[90:91], v7 offset:23552
    buffer_load_dwordx4 v[148:151], v11, s[40:43], s80 offen offset:1024 sc1
    ds_read_b64_tr_b16 a[92:93], v8 offset:22528
    ds_read_b64_tr_b16 a[94:95], v8 offset:23552
    ds_read_b64_tr_b16 a[96:97], v7 offset:24576
    ds_read_b64_tr_b16 a[98:99], v7 offset:25600
    ds_read_b64_tr_b16 a[100:101], v8 offset:24576
    ds_read_b64_tr_b16 a[102:103], v8 offset:25600
    buffer_load_dwordx4 v[152:155], v11, s[40:43], s80 offen offset:2048 sc1
    ds_read_b64_tr_b16 a[104:105], v7 offset:26624
    ds_read_b64_tr_b16 a[106:107], v7 offset:27648
    ds_read_b64_tr_b16 a[108:109], v8 offset:26624
    ds_read_b64_tr_b16 a[110:111], v8 offset:27648
    ds_read_b64_tr_b16 a[112:113], v7 offset:28672
    ds_read_b64_tr_b16 a[114:115], v7 offset:29696
    buffer_load_dwordx4 v[156:159], v11, s[40:43], s80 offen offset:3072 sc1
    ds_read_b64_tr_b16 a[116:117], v8 offset:28672
    ds_read_b64_tr_b16 a[118:119], v8 offset:29696
    ds_read_b64_tr_b16 a[120:121], v7 offset:30720
    ds_read_b64_tr_b16 a[122:123], v7 offset:31744
    ds_read_b64_tr_b16 a[124:125], v8 offset:30720
    ds_read_b64_tr_b16 a[126:127], v8 offset:31744
    s_add_u32 m0, s66, 0
    s_add_u32 s76, s74, 0
    buffer_load_dwordx4 v3, s[20:23], s76 offen lds
    buffer_load_dwordx4 v4, s[20:23], s76 offen offset:1024 lds
    s_lshl2_add_u32 s76, s50, s48
    s_lshl_b32 s76, s76, 11
    s_lshl_b32 s77, s49, 18
    s_add_u32 s76, s76, s77
    s_mov_b64 exec, 0xffff
    buffer_load_dword a200, v55, s[36:39], s76 offen
    s_mov_b64 exec, -1
    s_lshl_b32 s72, s48, 8
    s_add_u32 s72, s72, 139264
    v_and_b32 v30, 15, v1
    v_lshlrev_b32 v30, 4, v30
    v_lshrrev_b32 v31, 4, v1
    v_lshl_add_u32 v30, v31, 2, v30
    v_add_u32 v30, s72, v30
    v_lshlrev_b32 v31, 6, v31
    v_add_u32 v31, s72, v31
    s_lshl_b32 s72, s48, 11
    s_add_u32 s72, s72, 131072
    v_add_u32 v28, s72, v2
    v_add_u32 v29, 131072, v2
    s_waitcnt lgkmcnt(15)
    v_readfirstlane_b32 s95, v9
    s_waitcnt vmcnt(11)
    v_pk_add_f32 v[160:161], v[160:161], v[164:165]
    v_pk_add_f32 v[162:163], v[162:163], v[166:167]
    v_pk_add_f32 v[168:169], v[168:169], v[172:173]
    v_pk_add_f32 v[170:171], v[170:171], v[174:175]
    v_pk_add_f32 v[160:161], v[160:161], v[168:169]
    v_pk_add_f32 v[162:163], v[162:163], v[170:171]
    s_nop 1
    v_permlane32_swap_b32 v160, v162
    v_permlane32_swap_b32 v161, v163
    v_add_f32 v160, v160, v162
    v_add_f32 v161, v161, v163
    s_nop 1
    v_permlane16_swap_b32 v160, v161
    v_add_f32 v160, v160, v161
    ds_write_b32 v30, v160
    ds_read_b128 v[220:223], v31 offset:0
    ds_read_b128 v[224:227], v31 offset:16
    ds_read_b128 v[228:231], v31 offset:32
    ds_read_b128 v[232:235], v31 offset:48
    s_waitcnt vmcnt(10)
    v_dot2_f32_bf16 v176, v128, s69, 0
    v_dot2_f32_bf16 v177, v128, s70, 0
    v_dot2_f32_bf16 v178, v129, s69, 0
    v_dot2_f32_bf16 v179, v129, s70, 0
    v_dot2_f32_bf16 v180, v130, s69, 0
    v_dot2_f32_bf16 v181, v130, s70, 0
    v_dot2_f32_bf16 v182, v131, s69, 0
    v_dot2_f32_bf16 v183, v131, s70, 0
    s_waitcnt vmcnt(9)
    v_dot2c_f32_bf16 v176, s69, v132
    v_dot2c_f32_bf16 v177, s70, v132
    v_dot2c_f32_bf16 v178, s69, v133
    v_dot2c_f32_bf16 v179, s70, v133
    v_dot2c_f32_bf16 v180, s69, v134
    v_dot2c_f32_bf16 v181, s70, v134
    v_dot2c_f32_bf16 v182, s69, v135
    v_dot2c_f32_bf16 v183, s70, v135
    s_waitcnt vmcnt(8)
    v_dot2c_f32_bf16 v176, s69, v136
    v_dot2c_f32_bf16 v177, s70, v136
    v_dot2c_f32_bf16 v178, s69, v137
    v_dot2c_f32_bf16 v179, s70, v137
    v_dot2c_f32_bf16 v180, s69, v138
    v_dot2c_f32_bf16 v181, s70, v138
    v_dot2c_f32_bf16 v182, s69, v139
    v_dot2c_f32_bf16 v183, s70, v139
    s_waitcnt vmcnt(7)
    v_dot2c_f32_bf16 v176, s69, v140
    v_dot2c_f32_bf16 v177, s70, v140
    v_dot2c_f32_bf16 v178, s69, v141
    v_dot2c_f32_bf16 v179, s70, v141
    v_dot2c_f32_bf16 v180, s69, v142
    v_dot2c_f32_bf16 v181, s70, v142
    v_dot2c_f32_bf16 v182, s69, v143
    v_dot2c_f32_bf16 v183, s70, v143
    s_waitcnt vmcnt(6)
    v_dot2c_f32_bf16 v176, s69, v144
    v_dot2c_f32_bf16 v177, s70, v144
    v_dot2c_f32_bf16 v178, s69, v145
    v_dot2c_f32_bf16 v179, s70, v145
    v_dot2c_f32_bf16 v180, s69, v146
    v_dot2c_f32_bf16 v181, s70, v146
    v_dot2c_f32_bf16 v182, s69, v147
    v_dot2c_f32_bf16 v183, s70, v147
    s_waitcnt vmcnt(5)
    v_dot2c_f32_bf16 v176, s69, v148
    v_dot2c_f32_bf16 v177, s70, v148
    v_dot2c_f32_bf16 v178, s69, v149
    v_dot2c_f32_bf16 v179, s70, v149
    v_dot2c_f32_bf16 v180, s69, v150
    v_dot2c_f32_bf16 v181, s70, v150
    v_dot2c_f32_bf16 v182, s69, v151
    v_dot2c_f32_bf16 v183, s70, v151
    s_waitcnt vmcnt(4)
    v_dot2c_f32_bf16 v176, s69, v152
    v_dot2c_f32_bf16 v177, s70, v152
    v_dot2c_f32_bf16 v178, s69, v153
    v_dot2c_f32_bf16 v179, s70, v153
    v_dot2c_f32_bf16 v180, s69, v154
    v_dot2c_f32_bf16 v181, s70, v154
    v_dot2c_f32_bf16 v182, s69, v155
    v_dot2c_f32_bf16 v183, s70, v155
    s_waitcnt vmcnt(3)
    v_dot2c_f32_bf16 v176, s69, v156
    v_dot2c_f32_bf16 v177, s70, v156
    v_dot2c_f32_bf16 v178, s69, v157
    v_dot2c_f32_bf16 v179, s70, v157
    v_dot2c_f32_bf16 v180, s69, v158
    v_dot2c_f32_bf16 v181, s70, v158
    v_dot2c_f32_bf16 v182, s69, v159
    v_dot2c_f32_bf16 v183, s70, v159
    ds_write_b128 v28, v[176:179] offset:0
    s_nop 1
    ds_write_b128 v28, v[180:183] offset:1024
    s_waitcnt lgkmcnt(2)
    v_cvt_pk_bf16_f32 v136, v220, v221
    v_cvt_pk_bf16_f32 v137, v222, v223
    v_cvt_pk_bf16_f32 v138, v224, v225
    v_cvt_pk_bf16_f32 v139, v226, v227
    v_cvt_pk_bf16_f32 v140, v228, v229
    v_cvt_pk_bf16_f32 v141, v230, v231
    v_cvt_pk_bf16_f32 v142, v232, v233
    v_cvt_pk_bf16_f32 v143, v234, v235
    s_waitcnt vmcnt(1) lgkmcnt(0)
    s_barrier
    ds_read_b128 v[184:187], v29 offset:0
    ds_read_b128 v[188:191], v29 offset:1024
    ds_read_b128 v[200:203], v29 offset:4096
    ds_read_b128 v[204:207], v29 offset:5120
    ds_read_b128 v[192:195], v29 offset:2048
    ds_read_b128 v[196:199], v29 offset:3072
    ds_read_b128 v[208:211], v29 offset:6144
    ds_read_b128 v[212:215], v29 offset:7168
    s_and_b32 s72, s50, 1
    s_lshl_b32 s72, s72, 2
    s_add_u32 s72, s72, s48
    s_lshl_b32 s72, s72, 5
    s_lshl_b32 s73, s52, 1
    s_add_u32 s72, s72, s73
    s_lshl_b32 s72, s72, 10
    s_add_u32 s72, s72, s97
    s_waitcnt lgkmcnt(4)
    v_pk_add_f32 v[184:185], v[184:185], v[200:201]
    v_pk_add_f32 v[186:187], v[186:187], v[202:203]
    v_pk_add_f32 v[188:189], v[188:189], v[204:205]
    v_pk_add_f32 v[190:191], v[190:191], v[206:207]
    v_cvt_pk_bf16_f32 v128, v184, v185
    v_cvt_pk_bf16_f32 v129, v186, v187
    v_cvt_pk_bf16_f32 v130, v188, v189
    v_cvt_pk_bf16_f32 v131, v190, v191
    s_waitcnt lgkmcnt(0)
    v_pk_add_f32 v[192:193], v[192:193], v[208:209]
    v_pk_add_f32 v[194:195], v[194:195], v[210:211]
    v_pk_add_f32 v[196:197], v[196:197], v[212:213]
    v_pk_add_f32 v[198:199], v[198:199], v[214:215]
    v_cvt_pk_bf16_f32 v132, v192, v193
    v_cvt_pk_bf16_f32 v133, v194, v195
    v_cvt_pk_bf16_f32 v134, v196, v197
    v_cvt_pk_bf16_f32 v135, v198, v199
    v_cndmask_b32 v144, v128, v136, s[58:59]
    v_cndmask_b32 v145, v129, v137, s[58:59]
    v_cndmask_b32 v146, v130, v138, s[58:59]
    v_cndmask_b32 v147, v131, v139, s[58:59]
    v_cndmask_b32 v148, v132, v140, s[58:59]
    v_cndmask_b32 v149, v133, v141, s[58:59]
    v_cndmask_b32 v150, v134, v142, s[58:59]
    v_cndmask_b32 v151, v135, v143, s[58:59]
    v_mfma_f32_32x32x16_bf16 v[80:95], v[144:147], v[32:35], 0
    v_cndmask_b32 v152, v136, v128, s[58:59]
    v_cndmask_b32 v153, v137, v129, s[58:59]
    v_cndmask_b32 v154, v138, v130, s[58:59]
    v_cndmask_b32 v155, v139, v131, s[58:59]
    v_mfma_f32_32x32x16_bf16 v[80:95], v[148:151], v[36:39], v[80:95]
    v_cndmask_b32 v156, v140, v132, s[58:59]
    v_cndmask_b32 v157, v141, v133, s[58:59]
    v_cndmask_b32 v158, v142, v134, s[58:59]
    v_cndmask_b32 v159, v143, v135, s[58:59]
    v_mfma_f32_32x32x16_bf16 v[96:111], v[152:155], v[64:67], 0
    s_nop 0
    v_mfma_f32_32x32x16_bf16 v[96:111], v[156:159], v[68:71], v[96:111]
    ds_read_b64_tr_b16 a[0:1], v7 offset:0
    ds_read_b64_tr_b16 a[2:3], v7 offset:1024
    ds_read_b64_tr_b16 a[4:5], v8 offset:0
    ds_read_b64_tr_b16 a[6:7], v8 offset:1024
    ds_read_b64_tr_b16 a[64:65], v7 offset:16384
    ds_read_b64_tr_b16 a[66:67], v7 offset:17408
    ds_read_b64_tr_b16 a[68:69], v8 offset:16384
    ds_read_b64_tr_b16 a[70:71], v8 offset:17408
    v_add_f32 v28, 0x358637bd, v88
    v_rcp_f32 v28, v28
    s_nop 0
    v_pk_mul_f32 v[80:81], v[80:81], v[28:29] op_sel_hi:[1,0]
    v_pk_mul_f32 v[82:83], v[82:83], v[28:29] op_sel_hi:[1,0]
    v_pk_mul_f32 v[84:85], v[84:85], v[28:29] op_sel_hi:[1,0]
    v_pk_mul_f32 v[86:87], v[86:87], v[28:29] op_sel_hi:[1,0]
    v_cvt_pk_bf16_f32 v56, v80, v81
    v_cvt_pk_bf16_f32 v57, v82, v83
    v_cvt_pk_bf16_f32 v58, v84, v85
    v_cvt_pk_bf16_f32 v59, v86, v87
    v_add_f32 v28, 0x358637bd, v96
    v_rcp_f32 v28, v28
    s_nop 0
    v_pk_mul_f32 v[104:105], v[104:105], v[28:29] op_sel_hi:[1,0]
    v_pk_mul_f32 v[106:107], v[106:107], v[28:29] op_sel_hi:[1,0]
    v_pk_mul_f32 v[108:109], v[108:109], v[28:29] op_sel_hi:[1,0]
    v_pk_mul_f32 v[110:111], v[110:111], v[28:29] op_sel_hi:[1,0]
    v_cvt_pk_bf16_f32 v60, v104, v105
    v_cvt_pk_bf16_f32 v61, v106, v107
    v_cvt_pk_bf16_f32 v62, v108, v109
    v_cvt_pk_bf16_f32 v63, v110, v111
    s_cmp_lg_u32 s95, 0
    s_cbranch_scc1 FA_12
    buffer_store_dwordx4 v[56:59], v2, s[40:43], s72 offen offset:0 sc1
    buffer_store_dwordx4 v[60:63], v2, s[40:43], s72 offen offset:1024 sc1
    s_branch FB_13
FA_12:
    buffer_store_dwordx4 v[56:59], v2, s[40:43], s72 offen offset:0
    buffer_store_dwordx4 v[60:63], v2, s[40:43], s72 offen offset:1024
FB_13:
    s_xor_b32 s72, s48, 1
    s_lshl_b32 s72, s72, 12
    s_add_u32 s72, s72, 131072
    v_add_u32 v18, s72, v2
    s_lshl_b32 s72, s48, 12
    s_add_u32 s72, s72, 131072
    v_add_u32 v21, s72, v2
    s_and_b32 s74, s87, 7
    s_lshl_b32 s74, s74, 5
    s_and_b32 s73, s48, 1
    s_lshl_b32 s73, s73, 4
    s_add_u32 s74, s74, s73
    s_lshl_b32 s74, s74, 10
    s_add_u32 s74, s74, s97
    v_and_b32 v28, 31, v1
    v_bfe_u32 v29, v1, 1, 2
    v_lshlrev_b32 v28, 6, v28
    v_lshl_add_u32 v28, v25, 3, v28
    s_lshl_b32 s72, s48, 11
    s_add_u32 s72, s72, 141312
    v_add_u32 v28, s72, v28
    v_lshlrev_b32 v29, 4, v29
    v_xor_b32 v30, 0, v29
    v_add_u32 v30, v30, v28
    ds_read_b64 v[112:113], v30
    v_xor_b32 v30, 16, v29
    v_add_u32 v30, v30, v28
    ds_read_b64 v[114:115], v30
    v_xor_b32 v30, 32, v29
    v_add_u32 v30, v30, v28
    ds_read_b64 v[116:117], v30
    v_xor_b32 v30, 48, v29
    v_add_u32 v30, v30, v28
    ds_read_b64 v[118:119], v30
    s_waitcnt lgkmcnt(0)
    v_lshlrev_b32 v96, 16, v112
    v_and_b32 v97, s63, v112
    v_lshlrev_b32 v98, 16, v113
    v_and_b32 v99, s63, v113
    v_lshlrev_b32 v100, 16, v114
    v_and_b32 v101, s63, v114
    v_lshlrev_b32 v102, 16, v115
    v_and_b32 v103, s63, v115
    v_lshlrev_b32 v104, 16, v116
    v_and_b32 v105, s63, v116
    v_lshlrev_b32 v106, 16, v117
    v_and_b32 v107, s63, v117
    v_lshlrev_b32 v108, 16, v118
    v_and_b32 v109, s63, v118
    v_lshlrev_b32 v110, 16, v119
    v_and_b32 v111, s63, v119
    s_waitcnt vmcnt(0) lgkmcnt(0)
    s_barrier
    s_cmp_lg_u32 s48, 0
    s_cbranch_scc1 PUB_14
    s_lshl_b32 s72, s51, 4
    s_add_u32 s72, s72, s52
    s_lshl_b32 s72, s72, 7
    s_add_u32 s72, s72, 25231360
    v_mov_b32 v28, s54
    v_mov_b32 v29, s55
    s_mov_b64 exec, 1
    s_cmp_lg_u32 s95, 0
    s_cbranch_scc1 FA_15
    buffer_store_dwordx2 v[28:29], off, s[40:43], s72 sc1
    s_branch FB_16
FA_15:
    buffer_store_dwordx2 v[28:29], off, s[40:43], s72
FB_16:
    s_mov_b64 exec, -1
PUB_14:
    s_waitcnt lgkmcnt(0)
    s_cmp_lg_u32 s48, 0
    s_cbranch_scc1 POLLO_20
    s_lshl_b32 s72, s51, 11
    s_add_u32 s72, s72, 25231360
    v_min_u32 v30, 15, v1
    v_lshlrev_b32 v30, 7, v30
    s_mov_b32 s73, 0
POLL_19:
    buffer_load_dwordx2 v[28:29], v30, s[40:43], s72 offen sc1
    s_add_u32 s73, s73, 1
    s_waitcnt vmcnt(0)
    v_cmp_ne_u64 vcc, s[54:55], v[28:29]
    s_cmp_gt_u32 s73, 0x400000
    s_cbranch_scc1 POLLX_18
    s_cmp_lg_u64 vcc, 0
    s_cbranch_scc1 POLL_19
    s_branch POLLX_18
POLLO_20:
POLLX_18:
    s_barrier
    buffer_load_dwordx4 v[128:131], v2, s[40:43], s74 offen offset:0 sc1
    buffer_load_dwordx4 v[132:135], v2, s[40:43], s74 offen offset:1024 sc1
    buffer_load_dwordx4 v[136:139], v2, s[40:43], s74 offen offset:2048 sc1
    buffer_load_dwordx4 v[140:143], v2, s[40:43], s74 offen offset:3072 sc1
    s_add_u32 s74, s74, 4096
    buffer_load_dwordx4 v[144:147], v2, s[40:43], s74 offen offset:0 sc1
    buffer_load_dwordx4 v[148:151], v2, s[40:43], s74 offen offset:1024 sc1
    buffer_load_dwordx4 v[152:155], v2, s[40:43], s74 offen offset:2048 sc1
    buffer_load_dwordx4 v[156:159], v2, s[40:43], s74 offen offset:3072 sc1
    s_waitcnt vmcnt(7)
    v_mfma_f32_32x32x16_bf16 v[208:223], a[4:7], v[128:131], 0
    v_mfma_f32_32x32x16_bf16 v[192:207], a[0:3], v[128:131], 0
    s_add_u32 s74, s74, 4096
    buffer_load_dwordx4 v[160:163], v2, s[40:43], s74 offen offset:0 sc1
    s_waitcnt vmcnt(7)
    v_mfma_f32_32x32x16_bf16 v[208:223], a[12:15], v[132:135], v[208:223]
    v_mfma_f32_32x32x16_bf16 v[192:207], a[8:11], v[132:135], v[192:207]
    buffer_load_dwordx4 v[164:167], v2, s[40:43], s74 offen offset:1024 sc1
    s_waitcnt vmcnt(7)
    v_mfma_f32_32x32x16_bf16 v[208:223], a[20:23], v[136:139], v[208:223]
    v_mfma_f32_32x32x16_bf16 v[192:207], a[16:19], v[136:139], v[192:207]
    buffer_load_dwordx4 v[168:171], v2, s[40:43], s74 offen offset:2048 sc1
    s_waitcnt vmcnt(7)
    v_mfma_f32_32x32x16_bf16 v[208:223], a[28:31], v[140:143], v[208:223]
    v_mfma_f32_32x32x16_bf16 v[192:207], a[24:27], v[140:143], v[192:207]
    buffer_load_dwordx4 v[172:175], v2, s[40:43], s74 offen offset:3072 sc1
    s_waitcnt vmcnt(7)
    v_mfma_f32_32x32x16_bf16 v[208:223], a[36:39], v[144:147], v[208:223]
    v_mfma_f32_32x32x16_bf16 v[192:207], a[32:35], v[144:147], v[192:207]
    s_add_u32 s74, s74, 4096
    buffer_load_dwordx4 v[176:179], v2, s[40:43], s74 offen offset:0 sc1
    s_waitcnt vmcnt(7)
    v_mfma_f32_32x32x16_bf16 v[208:223], a[44:47], v[148:151], v[208:223]
    v_mfma_f32_32x32x16_bf16 v[192:207], a[40:43], v[148:151], v[192:207]
    buffer_load_dwordx4 v[180:183], v2, s[40:43], s74 offen offset:1024 sc1
    s_waitcnt vmcnt(7)
    v_mfma_f32_32x32x16_bf16 v[208:223], a[52:55], v[152:155], v[208:223]
    v_mfma_f32_32x32x16_bf16 v[192:207], a[48:51], v[152:155], v[192:207]
    buffer_load_dwordx4 v[184:187], v2, s[40:43], s74 offen offset:2048 sc1
    s_waitcnt vmcnt(7)
    v_mfma_f32_32x32x16_bf16 v[208:223], a[60:63], v[156:159], v[208:223]
    v_mfma_f32_32x32x16_bf16 v[192:207], a[56:59], v[156:159], v[192:207]
    buffer_load_dwordx4 v[188:191], v2, s[40:43], s74 offen offset:3072 sc1
    s_waitcnt vmcnt(7)
    v_mfma_f32_32x32x16_bf16 v[208:223], a[68:71], v[160:163], v[208:223]
    v_mfma_f32_32x32x16_bf16 v[192:207], a[64:67], v[160:163], v[192:207]
    s_waitcnt vmcnt(6)
    v_mfma_f32_32x32x16_bf16 v[208:223], a[76:79], v[164:167], v[208:223]
    v_mfma_f32_32x32x16_bf16 v[192:207], a[72:75], v[164:167], v[192:207]
    s_waitcnt vmcnt(5)
    v_mfma_f32_32x32x16_bf16 v[208:223], a[84:87], v[168:171], v[208:223]
    v_mfma_f32_32x32x16_bf16 v[192:207], a[80:83], v[168:171], v[192:207]
    s_waitcnt vmcnt(4)
    v_mfma_f32_32x32x16_bf16 v[208:223], a[92:95], v[172:175], v[208:223]
    v_mfma_f32_32x32x16_bf16 v[192:207], a[88:91], v[172:175], v[192:207]
    s_waitcnt vmcnt(3)
    v_mfma_f32_32x32x16_bf16 v[208:223], a[100:103], v[176:179], v[208:223]
    v_mfma_f32_32x32x16_bf16 v[192:207], a[96:99], v[176:179], v[192:207]
    s_add_u32 m0, s78, 32768
    s_add_u32 s79, s71, 458752
    buffer_load_dwordx4 v48, s[24:27], s79 offen lds
    s_waitcnt vmcnt(3)
    v_mfma_f32_32x32x16_bf16 v[208:223], a[108:111], v[180:183], v[208:223]
    s_add_u32 m0, s78, 33792
    s_add_u32 s79, s71, 487424
    buffer_load_dwordx4 v48, s[24:27], s79 offen lds
    s_waitcnt vmcnt(3)
    v_mfma_f32_32x32x16_bf16 v[208:223], a[116:119], v[184:187], v[208:223]
    s_add_u32 m0, s78, 34816
    s_add_u32 s79, s71, 516096
    buffer_load_dwordx4 v48, s[24:27], s79 offen lds
    s_waitcnt vmcnt(3)
    v_mfma_f32_32x32x16_bf16 v[208:223], a[124:127], v[188:191], v[208:223]
    s_add_u32 m0, s78, 35840
    s_add_u32 s79, s71, 544768
    buffer_load_dwordx4 v48, s[24:27], s79 offen lds
    s_lshl_b32 s72, s87, 5
    s_lshl_b32 s73, s57, 2
    s_add_u32 s72, s72, s73
    s_and_b32 s74, s48, 1
    s_lshl_b32 s73, s74, 1
    s_add_u32 s72, s72, s73
    s_lshl_b32 s72, s72, 10
    s_mov_b32 s75, s72
    v_mfma_f32_32x32x16_bf16 v[192:207], a[104:107], v[180:183], v[192:207]
    v_mfma_f32_32x32x16_bf16 v[192:207], a[112:115], v[184:187], v[192:207]
    ds_write_b128 v18, v[208:211] offset:0
    v_mfma_f32_32x32x16_bf16 v[192:207], a[120:123], v[188:191], v[192:207]
    ds_write_b128 v18, v[212:215] offset:1024
    ds_write_b128 v18, v[216:219] offset:2048
    ds_write_b128 v18, v[220:223] offset:3072
    s_nop 8
    v_pk_add_f32 v[96:97], v[96:97], v[192:193]
    v_pk_add_f32 v[98:99], v[98:99], v[194:195]
    v_pk_add_f32 v[100:101], v[100:101], v[196:197]
    v_pk_add_f32 v[102:103], v[102:103], v[198:199]
    v_pk_add_f32 v[104:105], v[104:105], v[200:201]
    v_pk_add_f32 v[106:107], v[106:107], v[202:203]
    v_pk_add_f32 v[108:109], v[108:109], v[204:205]
    v_pk_add_f32 v[110:111], v[110:111], v[206:207]
    s_waitcnt lgkmcnt(0)
    s_barrier
    ds_read_b128 v[128:131], v21 offset:0
    ds_read_b128 v[132:135], v21 offset:1024
    ds_read_b128 v[136:139], v21 offset:2048
    ds_read_b128 v[140:143], v21 offset:3072
    s_lshl_b32 s72, s49, 2
    s_add_u32 s72, s72, s56
    s_lshl_b32 s72, s72, 4
    s_lshl_b32 s73, s57, 1
    s_add_u32 s72, s72, s73
    s_add_u32 s72, s72, s74
    s_lshl_b32 s72, s72, 9
    s_lshr_b32 s73, s48, 1
    s_lshl_b32 s73, s73, 3
    s_add_u32 s72, s72, s73
    s_add_u32 s72, s72, 5242880
    s_waitcnt lgkmcnt(3)
    v_pk_add_f32 v[96:97], v[96:97], v[128:129]
    v_pk_add_f32 v[98:99], v[98:99], v[130:131]
    s_waitcnt lgkmcnt(2)
    v_pk_add_f32 v[100:101], v[100:101], v[132:133]
    v_pk_add_f32 v[102:103], v[102:103], v[134:135]
    v_cvt_pk_bf16_f32 v112, v96, v97
    v_cvt_pk_bf16_f32 v113, v98, v99
    v_cvt_pk_bf16_f32 v114, v100, v101
    v_cvt_pk_bf16_f32 v115, v102, v103
    s_waitcnt lgkmcnt(1)
    v_pk_add_f32 v[104:105], v[104:105], v[136:137]
    v_pk_add_f32 v[106:107], v[106:107], v[138:139]
    s_waitcnt lgkmcnt(0)
    v_pk_add_f32 v[108:109], v[108:109], v[140:141]
    v_pk_add_f32 v[110:111], v[110:111], v[142:143]
    v_cvt_pk_bf16_f32 v116, v104, v105
    v_cvt_pk_bf16_f32 v117, v106, v107
    v_cvt_pk_bf16_f32 v118, v108, v109
    v_cvt_pk_bf16_f32 v119, v110, v111
    s_cmp_lg_u32 s95, 0
    s_cbranch_scc1 FA_22
    buffer_store_dwordx4 v[112:115], v2, s[36:39], s75 offen offset:0 sc1
    buffer_store_dwordx4 v[116:119], v2, s[36:39], s75 offen offset:1024 sc1
    s_branch FB_23
FA_22:
    buffer_store_dwordx4 v[112:115], v2, s[36:39], s75 offen offset:0
    buffer_store_dwordx4 v[116:119], v2, s[36:39], s75 offen offset:1024
FB_23:
    v_dot2_f32_bf16 v28, v112, s62, 0
    v_dot2_f32_bf16 v29, v112, v112, 0
    v_dot2_f32_bf16 v30, v113, s62, 0
    v_dot2_f32_bf16 v31, v113, v113, 0
    v_dot2c_f32_bf16 v28, s62, v114
    v_dot2c_f32_bf16 v29, v114, v114
    v_dot2c_f32_bf16 v30, s62, v115
    v_dot2c_f32_bf16 v31, v115, v115
    v_dot2c_f32_bf16 v28, s62, v116
    v_dot2c_f32_bf16 v29, v116, v116
    v_dot2c_f32_bf16 v30, s62, v117
    v_dot2c_f32_bf16 v31, v117, v117
    v_dot2c_f32_bf16 v28, s62, v118
    v_dot2c_f32_bf16 v29, v118, v118
    v_dot2c_f32_bf16 v30, s62, v119
    v_dot2c_f32_bf16 v31, v119, v119
    s_nop 2
    v_pk_add_f32 v[28:29], v[28:29], v[30:31]
    s_nop 1
    v_permlane32_swap_b32 v28, v29
    v_add_f32 v28, v28, v29
    v_mov_b32 v29, v28
    s_nop 1
    v_permlane32_swap_b32 v28, v29
    s_mov_b32 exec_hi, 0
    s_cmp_lg_u32 s95, 0
    s_cbranch_scc1 FA_24
    buffer_store_dwordx2 v[28:29], v2, s[40:43], s72 offen sc1
    s_branch FB_25
FA_24:
    buffer_store_dwordx2 v[28:29], v2, s[40:43], s72 offen
FB_25:
    s_mov_b64 exec, -1
    v_lshlrev_b32 v96, 16, v112
    v_and_b32 v97, s63, v112
    v_lshlrev_b32 v98, 16, v113
    v_and_b32 v99, s63, v113
    v_lshlrev_b32 v100, 16, v114
    v_and_b32 v101, s63, v114
    v_lshlrev_b32 v102, 16, v115
    v_and_b32 v103, s63, v115
    v_lshlrev_b32 v104, 16, v116
    v_and_b32 v105, s63, v116
    v_lshlrev_b32 v106, 16, v117
    v_and_b32 v107, s63, v117
    v_lshlrev_b32 v108, 16, v118
    v_and_b32 v109, s63, v118
    v_lshlrev_b32 v110, 16, v119
    v_and_b32 v111, s63, v119
    v_mov_b32 v10, v48
    v_mov_b32 v11, v49
    v_lshrrev_b32 v28, 5, v1
    v_bfe_u32 v29, v1, 2, 2
    v_lshl_add_u32 v28, v28, 2, v29
    v_lshlrev_b32 v28, 7, v28
    v_bfe_u32 v30, v1, 4, 1
    v_lshl_add_u32 v28, v30, 14, v28
    v_and_b32 v31, 3, v1
    v_lshl_add_u32 v28, v31, 3, v28
    v_lshrrev_b32 v29, 1, v29
    v_lshl_add_u32 v29, v30, 1, v29
    s_xor_b32 s72, s48, 0
    v_xor_b32 v30, s72, v29
    v_lshl_add_u32 v24, v30, 5, v28
    s_xor_b32 s72, s48, 1
    v_xor_b32 v30, s72, v29
    v_lshl_add_u32 v25, v30, 5, v28
    s_xor_b32 s72, s48, 2
    v_xor_b32 v30, s72, v29
    v_lshl_add_u32 v26, v30, 5, v28
    s_xor_b32 s72, s48, 3
    v_xor_b32 v30, s72, v29
    v_lshl_add_u32 v27, v30, 5, v28
    s_lshl_b32 s67, s48, 13
    s_lshl_b32 s72, s48, 11
    s_sub_u32 s72, s72, 139264
    v_add_u32 v18, s72, v5
    v_add_u32 v19, s72, v6
    v_add_u32 v20, 65536, v18
    v_add_u32 v21, 65536, v19
    s_lshl_b32 s72, s49, 3
    s_lshl_b32 s73, s48, 1
    s_add_u32 s72, s72, s73
    s_lshl_b32 s72, s72, 15
    s_mov_b32 s82, s72
    s_lshl_b32 s72, s49, 2
    s_add_u32 s72, s72, s48
    s_lshl_b32 s72, s72, 13
    s_add_u32 s83, s72, 5242880
    s_add_u32 s84, s83, 4096
    s_mul_i32 s72, s48, 458752
    s_lshl_b32 s73, s57, 7
    s_add_u32 s94, s72, s73
    v_mov_b32 v7, 0
    v_mov_b32 v23, 0
    s_waitcnt vmcnt(0) lgkmcnt(0)
    s_barrier
    s_cmp_lg_u32 s48, 0
    s_cbranch_scc1 PUB_26
    s_lshl_b32 s72, s49, 5
    s_add_u32 s72, s72, s50
    s_lshl_b32 s72, s72, 7
    s_add_u32 s72, s72, 25296896
    v_mov_b32 v28, s54
    v_mov_b32 v29, s55
    s_mov_b64 exec, 1
    s_cmp_lg_u32 s95, 0
    s_cbranch_scc1 FA_27
    buffer_store_dwordx2 v[28:29], off, s[40:43], s72 sc1
    s_branch FB_28
FA_27:
    buffer_store_dwordx2 v[28:29], off, s[40:43], s72
FB_28:
    s_mov_b64 exec, -1
PUB_26:
    s_cmp_gt_u32 s50, 27
    s_cbranch_scc1 L_NOC
    s_cmp_lg_u32 s48, 0
    s_cbranch_scc1 POLLO_32
    s_lshl_b32 s72, s49, 12
    s_add_u32 s72, s72, 25296896
    v_min_u32 v30, 31, v1
    v_lshlrev_b32 v30, 7, v30
    s_mov_b32 s73, 0
POLL_31:
    s_nop 2
    buffer_load_dwordx2 v[28:29], v30, s[40:43], s72 offen sc1
    s_add_u32 s73, s73, 1
    s_waitcnt vmcnt(0)
    v_cmp_ne_u64 vcc, s[54:55], v[28:29]
    s_cmp_gt_u32 s73, 0x400000
    s_cbranch_scc1 POLLX_30
    s_cmp_lg_u64 vcc, 0
    s_cbranch_scc1 POLL_31
    s_branch POLLX_30
POLLO_32:
POLLX_30:
    s_barrier
    s_add_u32 s80, s82, 0
    s_add_u32 s81, s80, 32768
    buffer_load_dwordx4 v[64:67], v2, s[36:39], s80 offen offset:0 sc1
    buffer_load_dwordx4 v[68:71], v2, s[36:39], s81 offen offset:0 sc1
    buffer_load_dwordx4 v[72:75], v2, s[36:39], s80 offen offset:1024 sc1
    buffer_load_dwordx4 v[76:79], v2, s[36:39], s81 offen offset:1024 sc1
    buffer_load_dwordx4 v[80:83], v2, s[36:39], s80 offen offset:2048 sc1
    buffer_load_dwordx4 v[84:87], v2, s[36:39], s81 offen offset:2048 sc1
    ds_read_b64_tr_b16 v[32:33], v24 offset:0
    ds_read_b64_tr_b16 v[34:35], v24 offset:1024
    ds_read_b64_tr_b16 v[36:37], v25 offset:0
    ds_read_b64_tr_b16 v[38:39], v25 offset:1024
    ds_read_b64_tr_b16 v[40:41], v26 offset:0
    ds_read_b64_tr_b16 v[42:43], v26 offset:1024
    ds_read_b64_tr_b16 v[44:45], v27 offset:0
    ds_read_b64_tr_b16 v[46:47], v27 offset:1024
    s_waitcnt vmcnt(4) lgkmcnt(0)
    v_mfma_f32_32x32x16_bf16 v[128:143], v[32:35], v[64:67], 0
    ds_read_b64_tr_b16 v[48:49], v24 offset:2048
    ds_read_b64_tr_b16 v[50:51], v24 offset:3072
    buffer_load_dwordx4 v[88:91], v2, s[36:39], s80 offen offset:3072 sc1
    v_lshlrev_b32 v30, 16, v32
    v_mfma_f32_32x32x16_bf16 v[144:159], v[36:39], v[64:67], 0
    ds_read_b64_tr_b16 v[52:53], v25 offset:2048
    v_and_b32 v31, s63, v32
    v_add_f32 v7, v7, v30
    v_add_f32 v23, v23, v31
    v_mfma_f32_32x32x16_bf16 v[160:175], v[40:43], v[64:67], 0
    ds_read_b64_tr_b16 v[54:55], v25 offset:3072
    buffer_load_dwordx4 v[92:95], v2, s[36:39], s81 offen offset:3072 sc1
    v_lshlrev_b32 v30, 16, v33
    v_and_b32 v31, s63, v33
    v_mfma_f32_32x32x16_bf16 v[176:191], v[44:47], v[64:67], 0
    ds_read_b64_tr_b16 v[56:57], v26 offset:2048
    v_add_f32 v7, v7, v30
    v_add_f32 v23, v23, v31
    v_lshlrev_b32 v30, 16, v34
    v_mfma_f32_32x32x16_bf16 v[192:207], v[32:35], v[68:71], 0
    ds_read_b64_tr_b16 v[58:59], v26 offset:3072
    s_add_u32 s80, s82, 4096
    s_add_u32 s81, s80, 32768
    buffer_load_dwordx4 v[112:115], v2, s[36:39], s80 offen offset:0 sc1
    v_mfma_f32_32x32x16_bf16 v[208:223], v[36:39], v[68:71], 0
    ds_read_b64_tr_b16 v[60:61], v27 offset:2048
    v_and_b32 v31, s63, v34
    v_add_f32 v7, v7, v30
    v_add_f32 v23, v23, v31
    v_mfma_f32_32x32x16_bf16 v[224:239], v[40:43], v[68:71], 0
    ds_read_b64_tr_b16 v[62:63], v27 offset:3072
    buffer_load_dwordx4 v[116:119], v2, s[36:39], s81 offen offset:0 sc1
    v_lshlrev_b32 v30, 16, v35
    v_and_b32 v31, s63, v35
    v_mfma_f32_32x32x16_bf16 v[240:255], v[44:47], v[68:71], 0
    v_add_f32 v7, v7, v30
    v_add_f32 v23, v23, v31
    s_waitcnt vmcnt(6) lgkmcnt(0)
    v_mfma_f32_32x32x16_bf16 v[128:143], v[48:51], v[72:75], v[128:143]
    ds_read_b64_tr_b16 v[32:33], v24 offset:4096
    ds_read_b64_tr_b16 v[34:35], v24 offset:5120
    buffer_load_dwordx4 v[120:123], v2, s[36:39], s80 offen offset:1024 sc1
    v_lshlrev_b32 v30, 16, v48
    v_mfma_f32_32x32x16_bf16 v[144:159], v[52:55], v[72:75], v[144:159]
    ds_read_b64_tr_b16 v[36:37], v25 offset:4096
    v_and_b32 v31, s63, v48
    v_add_f32 v7, v7, v30
    v_add_f32 v23, v23, v31
    v_mfma_f32_32x32x16_bf16 v[160:175], v[56:59], v[72:75], v[160:175]
    ds_read_b64_tr_b16 v[38:39], v25 offset:5120
    buffer_load_dwordx4 v[124:127], v2, s[36:39], s81 offen offset:1024 sc1
    v_lshlrev_b32 v30, 16, v49
    v_and_b32 v31, s63, v49
    v_mfma_f32_32x32x16_bf16 v[176:191], v[60:63], v[72:75], v[176:191]
    ds_read_b64_tr_b16 v[40:41], v26 offset:4096
    v_add_f32 v7, v7, v30
    v_add_f32 v23, v23, v31
    v_lshlrev_b32 v30, 16, v50
    v_mfma_f32_32x32x16_bf16 v[192:207], v[48:51], v[76:79], v[192:207]
    ds_read_b64_tr_b16 v[42:43], v26 offset:5120
    s_add_u32 m0, s78, 49152
    s_add_u32 s79, s71, 458752
    buffer_load_dwordx4 v11, s[28:31], s79 offen lds
    v_mfma_f32_32x32x16_bf16 v[208:223], v[52:55], v[76:79], v[208:223]
    ds_read_b64_tr_b16 v[44:45], v27 offset:4096
    v_and_b32 v31, s63, v50
    v_add_f32 v7, v7, v30
    v_add_f32 v23, v23, v31
    v_mfma_f32_32x32x16_bf16 v[224:239], v[56:59], v[76:79], v[224:239]
    ds_read_b64_tr_b16 v[46:47], v27 offset:5120
    s_add_u32 m0, s78, 50176
    s_add_u32 s79, s71, 487424
    buffer_load_dwordx4 v11, s[28:31], s79 offen lds
    v_mfma_f32_32x32x16_bf16 v[240:255], v[60:63], v[76:79], v[240:255]
    v_lshlrev_b32 v30, 16, v51
    v_and_b32 v31, s63, v51
    v_add_f32 v7, v7, v30
    v_add_f32 v23, v23, v31
    s_waitcnt vmcnt(8) lgkmcnt(0)
    v_mfma_f32_32x32x16_bf16 v[128:143], v[32:35], v[80:83], v[128:143]
    ds_read_b64_tr_b16 v[48:49], v24 offset:6144
    ds_read_b64_tr_b16 v[50:51], v24 offset:7168
    buffer_load_dwordx4 a[224:227], v2, s[36:39], s80 offen offset:2048 sc1
    v_lshlrev_b32 v30, 16, v32
    v_mfma_f32_32x32x16_bf16 v[144:159], v[36:39], v[80:83], v[144:159]
    ds_read_b64_tr_b16 v[52:53], v25 offset:6144
    v_and_b32 v31, s63, v32
    v_add_f32 v7, v7, v30
    v_add_f32 v23, v23, v31
    v_mfma_f32_32x32x16_bf16 v[160:175], v[40:43], v[80:83], v[160:175]
    ds_read_b64_tr_b16 v[54:55], v25 offset:7168
    buffer_load_dwordx4 a[228:231], v2, s[36:39], s81 offen offset:2048 sc1
    v_lshlrev_b32 v30, 16, v33
    v_and_b32 v31, s63, v33
    v_mfma_f32_32x32x16_bf16 v[176:191], v[44:47], v[80:83], v[176:191]
    ds_read_b64_tr_b16 v[56:57], v26 offset:6144
    v_add_f32 v7, v7, v30
    v_add_f32 v23, v23, v31
    v_lshlrev_b32 v30, 16, v34
    v_mfma_f32_32x32x16_bf16 v[192:207], v[32:35], v[84:87], v[192:207]
    ds_read_b64_tr_b16 v[58:59], v26 offset:7168
    s_add_u32 m0, s78, 51200
    s_add_u32 s79, s71, 516096
    buffer_load_dwordx4 v11, s[28:31], s79 offen lds
    v_mfma_f32_32x32x16_bf16 v[208:223], v[36:39], v[84:87], v[208:223]
    ds_read_b64_tr_b16 v[60:61], v27 offset:6144
    v_and_b32 v31, s63, v34
    v_add_f32 v7, v7, v30
    v_add_f32 v23, v23, v31
    v_mfma_f32_32x32x16_bf16 v[224:239], v[40:43], v[84:87], v[224:239]
    ds_read_b64_tr_b16 v[62:63], v27 offset:7168
    s_add_u32 m0, s78, 52224
    s_add_u32 s79, s71, 544768
    buffer_load_dwordx4 v11, s[28:31], s79 offen lds
    v_mfma_f32_32x32x16_bf16 v[240:255], v[44:47], v[84:87], v[240:255]
    v_lshlrev_b32 v30, 16, v35
    v_and_b32 v31, s63, v35
    v_add_f32 v7, v7, v30
    v_add_f32 v23, v23, v31
    s_waitcnt vmcnt(10) lgkmcnt(0)
    v_mfma_f32_32x32x16_bf16 v[128:143], v[48:51], v[88:91], v[128:143]
    ds_read_b64_tr_b16 v[32:33], v24 offset:8192
    ds_read_b64_tr_b16 v[34:35], v24 offset:9216
    buffer_load_dwordx4 a[232:235], v2, s[36:39], s80 offen offset:3072 sc1
    v_lshlrev_b32 v30, 16, v48
    v_mfma_f32_32x32x16_bf16 v[144:159], v[52:55], v[88:91], v[144:159]
    ds_read_b64_tr_b16 v[36:37], v25 offset:8192
    v_and_b32 v31, s63, v48
    v_add_f32 v7, v7, v30
    v_add_f32 v23, v23, v31
    v_mfma_f32_32x32x16_bf16 v[160:175], v[56:59], v[88:91], v[160:175]
    ds_read_b64_tr_b16 v[38:39], v25 offset:9216
    buffer_load_dwordx4 a[236:239], v2, s[36:39], s81 offen offset:3072 sc1
    v_lshlrev_b32 v30, 16, v49
    v_and_b32 v31, s63, v49
    v_mfma_f32_32x32x16_bf16 v[176:191], v[60:63], v[88:91], v[176:191]
    ds_read_b64_tr_b16 v[40:41], v26 offset:8192
    v_add_f32 v7, v7, v30
    v_add_f32 v23, v23, v31
    v_lshlrev_b32 v30, 16, v50
    v_mfma_f32_32x32x16_bf16 v[192:207], v[48:51], v[92:95], v[192:207]
    ds_read_b64_tr_b16 v[42:43], v26 offset:9216
    s_add_u32 m0, s78, 65536
    s_add_u32 s79, s71, 917504
    buffer_load_dwordx4 v10, s[24:27], s79 offen lds
    v_mfma_f32_32x32x16_bf16 v[208:223], v[52:55], v[92:95], v[208:223]
    ds_read_b64_tr_b16 v[44:45], v27 offset:8192
    v_and_b32 v31, s63, v50
    v_add_f32 v7, v7, v30
    v_add_f32 v23, v23, v31
    v_mfma_f32_32x32x16_bf16 v[224:239], v[56:59], v[92:95], v[224:239]
    ds_read_b64_tr_b16 v[46:47], v27 offset:9216
    s_add_u32 m0, s78, 66560
    s_add_u32 s79, s71, 946176
    buffer_load_dwordx4 v10, s[24:27], s79 offen lds
    v_mfma_f32_32x32x16_bf16 v[240:255], v[60:63], v[92:95], v[240:255]
    v_lshlrev_b32 v30, 16, v51
    v_and_b32 v31, s63, v51
    v_add_f32 v7, v7, v30
    v_add_f32 v23, v23, v31
    s_waitcnt vmcnt(12) lgkmcnt(0)
    v_mfma_f32_32x32x16_bf16 v[128:143], v[32:35], v[112:115], v[128:143]
    ds_read_b64_tr_b16 v[48:49], v24 offset:10240
    ds_read_b64_tr_b16 v[50:51], v24 offset:11264
    s_add_u32 s80, s82, 8192
    s_add_u32 s81, s80, 32768
    buffer_load_dwordx4 a[240:243], v2, s[36:39], s80 offen offset:0 sc1
    v_mfma_f32_32x32x16_bf16 v[144:159], v[36:39], v[112:115], v[144:159]
    ds_read_b64_tr_b16 v[52:53], v25 offset:10240
    v_lshlrev_b32 v30, 16, v32
    v_and_b32 v31, s63, v32
    v_add_f32 v7, v7, v30
    v_mfma_f32_32x32x16_bf16 v[160:175], v[40:43], v[112:115], v[160:175]
    ds_read_b64_tr_b16 v[54:55], v25 offset:11264
    buffer_load_dwordx4 a[244:247], v2, s[36:39], s81 offen offset:0 sc1
    v_add_f32 v23, v23, v31
    v_lshlrev_b32 v30, 16, v33
    v_mfma_f32_32x32x16_bf16 v[176:191], v[44:47], v[112:115], v[176:191]
    ds_read_b64_tr_b16 v[56:57], v26 offset:10240
    v_and_b32 v31, s63, v33
    v_add_f32 v7, v7, v30
    v_add_f32 v23, v23, v31
    v_mfma_f32_32x32x16_bf16 v[192:207], v[32:35], v[116:119], v[192:207]
    ds_read_b64_tr_b16 v[58:59], v26 offset:11264
    buffer_load_dwordx4 a[248:251], v2, s[36:39], s80 offen offset:1024 sc1
    v_lshlrev_b32 v30, 16, v34
    v_and_b32 v31, s63, v34
    v_mfma_f32_32x32x16_bf16 v[208:223], v[36:39], v[116:119], v[208:223]
    ds_read_b64_tr_b16 v[60:61], v27 offset:10240
    v_add_f32 v7, v7, v30
    v_add_f32 v23, v23, v31
    v_lshlrev_b32 v30, 16, v35
    v_mfma_f32_32x32x16_bf16 v[224:239], v[40:43], v[116:119], v[224:239]
    ds_read_b64_tr_b16 v[62:63], v27 offset:11264
    buffer_load_dwordx4 a[252:255], v2, s[36:39], s81 offen offset:1024 sc1
    v_and_b32 v31, s63, v35
    v_add_f32 v7, v7, v30
    v_mfma_f32_32x32x16_bf16 v[240:255], v[44:47], v[116:119], v[240:255]
    v_add_f32 v23, v23, v31
    s_waitcnt vmcnt(14) lgkmcnt(0)
    v_mfma_f32_32x32x16_bf16 v[128:143], v[48:51], v[120:123], v[128:143]
    ds_read_b64_tr_b16 v[32:33], v24 offset:12288
    ds_read_b64_tr_b16 v[34:35], v24 offset:13312
    buffer_load_dwordx4 v[64:67], v2, s[36:39], s80 offen offset:2048 sc1
    v_lshlrev_b32 v30, 16, v48
    v_mfma_f32_32x32x16_bf16 v[144:159], v[52:55], v[120:123], v[144:159]
    ds_read_b64_tr_b16 v[36:37], v25 offset:12288
    v_and_b32 v31, s63, v48
    v_add_f32 v7, v7, v30
    v_add_f32 v23, v23, v31
    v_mfma_f32_32x32x16_bf16 v[160:175], v[56:59], v[120:123], v[160:175]
    ds_read_b64_tr_b16 v[38:39], v25 offset:13312
    buffer_load_dwordx4 v[68:71], v2, s[36:39], s81 offen offset:2048 sc1
    v_lshlrev_b32 v30, 16, v49
    v_and_b32 v31, s63, v49
    v_mfma_f32_32x32x16_bf16 v[176:191], v[60:63], v[120:123], v[176:191]
    ds_read_b64_tr_b16 v[40:41], v26 offset:12288
    v_add_f32 v7, v7, v30
    v_add_f32 v23, v23, v31
    v_lshlrev_b32 v30, 16, v50
    v_mfma_f32_32x32x16_bf16 v[192:207], v[48:51], v[124:127], v[192:207]
    ds_read_b64_tr_b16 v[42:43], v26 offset:13312
    s_add_u32 m0, s78, 67584
    s_add_u32 s79, s71, 974848
    buffer_load_dwordx4 v10, s[24:27], s79 offen lds
    v_mfma_f32_32x32x16_bf16 v[208:223], v[52:55], v[124:127], v[208:223]
    ds_read_b64_tr_b16 v[44:45], v27 offset:12288
    v_and_b32 v31, s63, v50
    v_add_f32 v7, v7, v30
    v_add_f32 v23, v23, v31
    v_mfma_f32_32x32x16_bf16 v[224:239], v[56:59], v[124:127], v[224:239]
    ds_read_b64_tr_b16 v[46:47], v27 offset:13312
    s_add_u32 m0, s78, 68608
    s_add_u32 s79, s71, 1003520
    buffer_load_dwordx4 v10, s[24:27], s79 offen lds
    v_mfma_f32_32x32x16_bf16 v[240:255], v[60:63], v[124:127], v[240:255]
    v_lshlrev_b32 v30, 16, v51
    v_and_b32 v31, s63, v51
    v_add_f32 v7, v7, v30
    v_add_f32 v23, v23, v31
    s_waitcnt vmcnt(14) lgkmcnt(0)
    v_mfma_f32_32x32x16_bf16 v[128:143], v[32:35], a[224:227], v[128:143]
    ds_read_b64_tr_b16 v[48:49], v24 offset:14336
    ds_read_b64_tr_b16 v[50:51], v24 offset:15360
    buffer_load_dwordx4 v[72:75], v2, s[36:39], s80 offen offset:3072 sc1
    v_lshlrev_b32 v30, 16, v32
    v_mfma_f32_32x32x16_bf16 v[144:159], v[36:39], a[224:227], v[144:159]
    ds_read_b64_tr_b16 v[52:53], v25 offset:14336
    v_and_b32 v31, s63, v32
    v_add_f32 v7, v7, v30
    v_add_f32 v23, v23, v31
    v_mfma_f32_32x32x16_bf16 v[160:175], v[40:43], a[224:227], v[160:175]
    ds_read_b64_tr_b16 v[54:55], v25 offset:15360
    buffer_load_dwordx4 v[76:79], v2, s[36:39], s81 offen offset:3072 sc1
    v_lshlrev_b32 v30, 16, v33
    v_and_b32 v31, s63, v33
    v_mfma_f32_32x32x16_bf16 v[176:191], v[44:47], a[224:227], v[176:191]
    ds_read_b64_tr_b16 v[56:57], v26 offset:14336
    v_add_f32 v7, v7, v30
    v_add_f32 v23, v23, v31
    v_lshlrev_b32 v30, 16, v34
    v_mfma_f32_32x32x16_bf16 v[192:207], v[32:35], a[228:231], v[192:207]
    ds_read_b64_tr_b16 v[58:59], v26 offset:15360
    s_add_u32 s80, s82, 12288
    s_add_u32 s81, s80, 32768
    buffer_load_dwordx4 v[80:83], v2, s[36:39], s80 offen offset:0 sc1
    v_mfma_f32_32x32x16_bf16 v[208:223], v[36:39], a[228:231], v[208:223]
    ds_read_b64_tr_b16 v[60:61], v27 offset:14336
    v_and_b32 v31, s63, v34
    v_add_f32 v7, v7, v30
    v_add_f32 v23, v23, v31
    v_mfma_f32_32x32x16_bf16 v[224:239], v[40:43], a[228:231], v[224:239]
    ds_read_b64_tr_b16 v[62:63], v27 offset:15360
    buffer_load_dwordx4 v[84:87], v2, s[36:39], s81 offen offset:0 sc1
    v_lshlrev_b32 v30, 16, v35
    v_and_b32 v31, s63, v35
    v_mfma_f32_32x32x16_bf16 v[240:255], v[44:47], a[228:231], v[240:255]
    v_add_f32 v7, v7, v30
    v_add_f32 v23, v23, v31
    s_waitcnt vmcnt(14) lgkmcnt(0)
    v_mfma_f32_32x32x16_bf16 v[128:143], v[48:51], a[232:235], v[128:143]
    s_barrier
    ds_read_b64_tr_b16 v[32:33], v24 offset:32768
    buffer_load_dwordx4 v[88:91], v2, s[36:39], s80 offen offset:1024 sc1
    v_lshlrev_b32 v30, 16, v48
    v_and_b32 v31, s63, v48
    v_mfma_f32_32x32x16_bf16 v[144:159], v[52:55], a[232:235], v[144:159]
    ds_read_b64_tr_b16 v[34:35], v24 offset:33792
    v_add_f32 v7, v7, v30
    v_add_f32 v23, v23, v31
    v_lshlrev_b32 v30, 16, v49
    v_and_b32 v31, s63, v49
    v_mfma_f32_32x32x16_bf16 v[160:175], v[56:59], a[232:235], v[160:175]
    ds_read_b64_tr_b16 v[36:37], v25 offset:32768
    buffer_load_dwordx4 v[92:95], v2, s[36:39], s81 offen offset:1024 sc1
    v_add_f32 v7, v7, v30
    v_add_f32 v23, v23, v31
    v_lshlrev_b32 v30, 16, v50
    v_mfma_f32_32x32x16_bf16 v[176:191], v[60:63], a[232:235], v[176:191]
    ds_read_b64_tr_b16 v[38:39], v25 offset:33792
    ds_read_b64_tr_b16 v[40:41], v26 offset:32768
    v_and_b32 v31, s63, v50
    v_add_f32 v7, v7, v30
    v_add_f32 v23, v23, v31
    v_mfma_f32_32x32x16_bf16 v[192:207], v[48:51], a[236:239], v[192:207]
    ds_read_b64_tr_b16 v[42:43], v26 offset:33792
    s_add_u32 m0, s78, 81920
    s_add_u32 s79, s71, 917504
    buffer_load_dwordx4 v11, s[28:31], s79 offen lds
    v_lshlrev_b32 v30, 16, v51
    v_mfma_f32_32x32x16_bf16 v[208:223], v[52:55], a[236:239], v[208:223]
    ds_read_b64_tr_b16 v[44:45], v27 offset:32768
    v_and_b32 v31, s63, v51
    v_add_f32 v7, v7, v30
    v_add_f32 v23, v23, v31
    v_mfma_f32_32x32x16_bf16 v[224:239], v[56:59], a[236:239], v[224:239]
    ds_read_b64_tr_b16 v[46:47], v27 offset:33792
    s_add_u32 m0, s78, 82944
    s_add_u32 s79, s71, 946176
    buffer_load_dwordx4 v11, s[28:31], s79 offen lds
    v_mfma_f32_32x32x16_bf16 v[240:255], v[60:63], a[236:239], v[240:255]
    s_waitcnt vmcnt(14) lgkmcnt(0)
    v_mfma_f32_32x32x16_bf16 v[128:143], v[32:35], a[240:243], v[128:143]
    ds_read_b64_tr_b16 v[48:49], v24 offset:34816
    ds_read_b64_tr_b16 v[50:51], v24 offset:35840
    buffer_load_dwordx4 v[112:115], v2, s[36:39], s80 offen offset:2048 sc1
    v_lshlrev_b32 v30, 16, v32
    v_mfma_f32_32x32x16_bf16 v[144:159], v[36:39], a[240:243], v[144:159]
    ds_read_b64_tr_b16 v[52:53], v25 offset:34816
    v_and_b32 v31, s63, v32
    v_add_f32 v7, v7, v30
    v_add_f32 v23, v23, v31
    v_mfma_f32_32x32x16_bf16 v[160:175], v[40:43], a[240:243], v[160:175]
    ds_read_b64_tr_b16 v[54:55], v25 offset:35840
    buffer_load_dwordx4 v[116:119], v2, s[36:39], s81 offen offset:2048 sc1
    v_lshlrev_b32 v30, 16, v33
    v_and_b32 v31, s63, v33
    v_mfma_f32_32x32x16_bf16 v[176:191], v[44:47], a[240:243], v[176:191]
    ds_read_b64_tr_b16 v[56:57], v26 offset:34816
    v_add_f32 v7, v7, v30
    v_add_f32 v23, v23, v31
    v_lshlrev_b32 v30, 16, v34
    v_mfma_f32_32x32x16_bf16 v[192:207], v[32:35], a[244:247], v[192:207]
    ds_read_b64_tr_b16 v[58:59], v26 offset:35840
    buffer_load_dwordx4 a[0:3], v2, s[40:43], s83 offen offset:0 sc1
    v_and_b32 v31, s63, v34
    v_add_f32 v7, v7, v30
    v_mfma_f32_32x32x16_bf16 v[208:223], v[36:39], a[244:247], v[208:223]
    ds_read_b64_tr_b16 v[60:61], v27 offset:34816
    v_add_f32 v23, v23, v31
    v_lshlrev_b32 v30, 16, v35
    v_and_b32 v31, s63, v35
    v_mfma_f32_32x32x16_bf16 v[224:239], v[40:43], a[244:247], v[224:239]
    ds_read_b64_tr_b16 v[62:63], v27 offset:35840
    buffer_load_dwordx4 a[4:7], v2, s[40:43], s83 offen offset:1024 sc1
    v_add_f32 v7, v7, v30
    v_add_f32 v23, v23, v31
    v_mfma_f32_32x32x16_bf16 v[240:255], v[44:47], a[244:247], v[240:255]
    s_waitcnt vmcnt(16) lgkmcnt(0)
    v_mfma_f32_32x32x16_bf16 v[128:143], v[48:51], a[248:251], v[128:143]
    ds_read_b64_tr_b16 v[32:33], v24 offset:36864
    ds_read_b64_tr_b16 v[34:35], v24 offset:37888
    buffer_load_dwordx4 v[120:123], v2, s[36:39], s80 offen offset:3072 sc1
    v_lshlrev_b32 v30, 16, v48
    v_mfma_f32_32x32x16_bf16 v[144:159], v[52:55], a[248:251], v[144:159]
    ds_read_b64_tr_b16 v[36:37], v25 offset:36864
    v_and_b32 v31, s63, v48
    v_add_f32 v7, v7, v30
    v_add_f32 v23, v23, v31
    v_mfma_f32_32x32x16_bf16 v[160:175], v[56:59], a[248:251], v[160:175]
    ds_read_b64_tr_b16 v[38:39], v25 offset:37888
    buffer_load_dwordx4 v[124:127], v2, s[36:39], s81 offen offset:3072 sc1
    v_lshlrev_b32 v30, 16, v49
    v_and_b32 v31, s63, v49
    v_mfma_f32_32x32x16_bf16 v[176:191], v[60:63], a[248:251], v[176:191]
    ds_read_b64_tr_b16 v[40:41], v26 offset:36864
    v_add_f32 v7, v7, v30
    v_add_f32 v23, v23, v31
    v_lshlrev_b32 v30, 16, v50
    v_mfma_f32_32x32x16_bf16 v[192:207], v[48:51], a[252:255], v[192:207]
    ds_read_b64_tr_b16 v[42:43], v26 offset:37888
    s_add_u32 m0, s78, 83968
    s_add_u32 s79, s71, 974848
    buffer_load_dwordx4 v11, s[28:31], s79 offen lds
    v_mfma_f32_32x32x16_bf16 v[208:223], v[52:55], a[252:255], v[208:223]
    ds_read_b64_tr_b16 v[44:45], v27 offset:36864
    v_and_b32 v31, s63, v50
    v_add_f32 v7, v7, v30
    v_add_f32 v23, v23, v31
    v_mfma_f32_32x32x16_bf16 v[224:239], v[56:59], a[252:255], v[224:239]
    ds_read_b64_tr_b16 v[46:47], v27 offset:37888
    s_add_u32 m0, s78, 84992
    s_add_u32 s79, s71, 1003520
    buffer_load_dwordx4 v11, s[28:31], s79 offen lds
    v_mfma_f32_32x32x16_bf16 v[240:255], v[60:63], a[252:255], v[240:255]
    v_lshlrev_b32 v30, 16, v51
    v_and_b32 v31, s63, v51
    v_add_f32 v7, v7, v30
    v_add_f32 v23, v23, v31
    s_waitcnt vmcnt(18) lgkmcnt(0)
    v_mfma_f32_32x32x16_bf16 v[128:143], v[32:35], v[64:67], v[128:143]
    ds_read_b64_tr_b16 v[48:49], v24 offset:38912
    ds_read_b64_tr_b16 v[50:51], v24 offset:39936
    s_add_u32 s80, s82, 16384
    s_add_u32 s81, s80, 32768
    buffer_load_dwordx4 a[224:227], v2, s[36:39], s80 offen offset:0 sc1
    v_mfma_f32_32x32x16_bf16 v[144:159], v[36:39], v[64:67], v[144:159]
    ds_read_b64_tr_b16 v[52:53], v25 offset:38912
    v_lshlrev_b32 v30, 16, v32
    v_and_b32 v31, s63, v32
    v_add_f32 v7, v7, v30
    v_mfma_f32_32x32x16_bf16 v[160:175], v[40:43], v[64:67], v[160:175]
    ds_read_b64_tr_b16 v[54:55], v25 offset:39936
    buffer_load_dwordx4 a[228:231], v2, s[36:39], s81 offen offset:0 sc1
    v_add_f32 v23, v23, v31
    v_lshlrev_b32 v30, 16, v33
    v_mfma_f32_32x32x16_bf16 v[176:191], v[44:47], v[64:67], v[176:191]
    ds_read_b64_tr_b16 v[56:57], v26 offset:38912
    v_and_b32 v31, s63, v33
    v_add_f32 v7, v7, v30
    v_add_f32 v23, v23, v31
    v_mfma_f32_32x32x16_bf16 v[192:207], v[32:35], v[68:71], v[192:207]
    ds_read_b64_tr_b16 v[58:59], v26 offset:39936
    buffer_load_dwordx4 a[8:11], v2, s[40:43], s83 offen offset:2048 sc1
    v_lshlrev_b32 v30, 16, v34
    v_and_b32 v31, s63, v34
    v_mfma_f32_32x32x16_bf16 v[208:223], v[36:39], v[68:71], v[208:223]
    ds_read_b64_tr_b16 v[60:61], v27 offset:38912
    v_add_f32 v7, v7, v30
    v_add_f32 v23, v23, v31
    v_lshlrev_b32 v30, 16, v35
    v_mfma_f32_32x32x16_bf16 v[224:239], v[40:43], v[68:71], v[224:239]
    ds_read_b64_tr_b16 v[62:63], v27 offset:39936
    buffer_load_dwordx4 a[12:15], v2, s[40:43], s83 offen offset:3072 sc1
    v_and_b32 v31, s63, v35
    v_add_f32 v7, v7, v30
    v_mfma_f32_32x32x16_bf16 v[240:255], v[44:47], v[68:71], v[240:255]
    v_add_f32 v23, v23, v31
    s_waitcnt vmcnt(18) lgkmcnt(0)
    v_mfma_f32_32x32x16_bf16 v[128:143], v[48:51], v[72:75], v[128:143]
    ds_read_b64_tr_b16 v[32:33], v24 offset:40960
    ds_read_b64_tr_b16 v[34:35], v24 offset:41984
    buffer_load_dwordx4 a[232:235], v2, s[36:39], s80 offen offset:1024 sc1
    v_lshlrev_b32 v30, 16, v48
    v_mfma_f32_32x32x16_bf16 v[144:159], v[52:55], v[72:75], v[144:159]
    ds_read_b64_tr_b16 v[36:37], v25 offset:40960
    v_and_b32 v31, s63, v48
    v_add_f32 v7, v7, v30
    v_add_f32 v23, v23, v31
    v_mfma_f32_32x32x16_bf16 v[160:175], v[56:59], v[72:75], v[160:175]
    ds_read_b64_tr_b16 v[38:39], v25 offset:41984
    buffer_load_dwordx4 a[236:239], v2, s[36:39], s81 offen offset:1024 sc1
    v_lshlrev_b32 v30, 16, v49
    v_and_b32 v31, s63, v49
    v_mfma_f32_32x32x16_bf16 v[176:191], v[60:63], v[72:75], v[176:191]
    ds_read_b64_tr_b16 v[40:41], v26 offset:40960
    v_add_f32 v7, v7, v30
    v_add_f32 v23, v23, v31
    v_lshlrev_b32 v30, 16, v50
    v_mfma_f32_32x32x16_bf16 v[192:207], v[48:51], v[76:79], v[192:207]
    ds_read_b64_tr_b16 v[42:43], v26 offset:41984
    s_add_u32 m0, s78, 98304
    s_add_u32 s79, s71, 1376256
    buffer_load_dwordx4 v10, s[24:27], s79 offen lds
    v_mfma_f32_32x32x16_bf16 v[208:223], v[52:55], v[76:79], v[208:223]
    ds_read_b64_tr_b16 v[44:45], v27 offset:40960
    v_and_b32 v31, s63, v50
    v_add_f32 v7, v7, v30
    v_add_f32 v23, v23, v31
    v_mfma_f32_32x32x16_bf16 v[224:239], v[56:59], v[76:79], v[224:239]
    ds_read_b64_tr_b16 v[46:47], v27 offset:41984
    s_add_u32 m0, s78, 99328
    s_add_u32 s79, s71, 1404928
    buffer_load_dwordx4 v10, s[24:27], s79 offen lds
    v_mfma_f32_32x32x16_bf16 v[240:255], v[60:63], v[76:79], v[240:255]
    v_lshlrev_b32 v30, 16, v51
    v_and_b32 v31, s63, v51
    v_add_f32 v7, v7, v30
    v_add_f32 v23, v23, v31
    s_waitcnt vmcnt(20) lgkmcnt(0)
    v_mfma_f32_32x32x16_bf16 v[128:143], v[32:35], v[80:83], v[128:143]
    ds_read_b64_tr_b16 v[48:49], v24 offset:43008
    ds_read_b64_tr_b16 v[50:51], v24 offset:44032
    buffer_load_dwordx4 a[240:243], v2, s[36:39], s80 offen offset:2048 sc1
    v_lshlrev_b32 v30, 16, v32
    v_mfma_f32_32x32x16_bf16 v[144:159], v[36:39], v[80:83], v[144:159]
    ds_read_b64_tr_b16 v[52:53], v25 offset:43008
    v_and_b32 v31, s63, v32
    v_add_f32 v7, v7, v30
    v_add_f32 v23, v23, v31
    v_mfma_f32_32x32x16_bf16 v[160:175], v[40:43], v[80:83], v[160:175]
    ds_read_b64_tr_b16 v[54:55], v25 offset:44032
    buffer_load_dwordx4 a[244:247], v2, s[36:39], s81 offen offset:2048 sc1
    v_lshlrev_b32 v30, 16, v33
    v_and_b32 v31, s63, v33
    v_mfma_f32_32x32x16_bf16 v[176:191], v[44:47], v[80:83], v[176:191]
    ds_read_b64_tr_b16 v[56:57], v26 offset:43008
    v_add_f32 v7, v7, v30
    v_add_f32 v23, v23, v31
    v_lshlrev_b32 v30, 16, v34
    v_mfma_f32_32x32x16_bf16 v[192:207], v[32:35], v[84:87], v[192:207]
    ds_read_b64_tr_b16 v[58:59], v26 offset:44032
    buffer_load_dwordx4 a[16:19], v2, s[40:43], s84 offen offset:0 sc1
    v_and_b32 v31, s63, v34
    v_add_f32 v7, v7, v30
    v_mfma_f32_32x32x16_bf16 v[208:223], v[36:39], v[84:87], v[208:223]
    ds_read_b64_tr_b16 v[60:61], v27 offset:43008
    v_add_f32 v23, v23, v31
    v_lshlrev_b32 v30, 16, v35
    v_and_b32 v31, s63, v35
    v_mfma_f32_32x32x16_bf16 v[224:239], v[40:43], v[84:87], v[224:239]
    ds_read_b64_tr_b16 v[62:63], v27 offset:44032
    buffer_load_dwordx4 a[20:23], v2, s[40:43], s84 offen offset:1024 sc1
    v_add_f32 v7, v7, v30
    v_add_f32 v23, v23, v31
    v_mfma_f32_32x32x16_bf16 v[240:255], v[44:47], v[84:87], v[240:255]
    s_waitcnt vmcnt(22) lgkmcnt(0)
    v_mfma_f32_32x32x16_bf16 v[128:143], v[48:51], v[88:91], v[128:143]
    ds_read_b64_tr_b16 v[32:33], v24 offset:45056
    ds_read_b64_tr_b16 v[34:35], v24 offset:46080
    buffer_load_dwordx4 a[248:251], v2, s[36:39], s80 offen offset:3072 sc1
    v_lshlrev_b32 v30, 16, v48
    v_mfma_f32_32x32x16_bf16 v[144:159], v[52:55], v[88:91], v[144:159]
    ds_read_b64_tr_b16 v[36:37], v25 offset:45056
    v_and_b32 v31, s63, v48
    v_add_f32 v7, v7, v30
    v_add_f32 v23, v23, v31
    v_mfma_f32_32x32x16_bf16 v[160:175], v[56:59], v[88:91], v[160:175]
    ds_read_b64_tr_b16 v[38:39], v25 offset:46080
    buffer_load_dwordx4 a[252:255], v2, s[36:39], s81 offen offset:3072 sc1
    v_lshlrev_b32 v30, 16, v49
    v_and_b32 v31, s63, v49
    v_mfma_f32_32x32x16_bf16 v[176:191], v[60:63], v[88:91], v[176:191]
    ds_read_b64_tr_b16 v[40:41], v26 offset:45056
    v_add_f32 v7, v7, v30
    v_add_f32 v23, v23, v31
    v_lshlrev_b32 v30, 16, v50
    v_mfma_f32_32x32x16_bf16 v[192:207], v[48:51], v[92:95], v[192:207]
    ds_read_b64_tr_b16 v[42:43], v26 offset:46080
    s_add_u32 m0, s78, 100352
    s_add_u32 s79, s71, 1433600
    buffer_load_dwordx4 v10, s[24:27], s79 offen lds
    v_mfma_f32_32x32x16_bf16 v[208:223], v[52:55], v[92:95], v[208:223]
    ds_read_b64_tr_b16 v[44:45], v27 offset:45056
    v_and_b32 v31, s63, v50
    v_add_f32 v7, v7, v30
    v_add_f32 v23, v23, v31
    v_mfma_f32_32x32x16_bf16 v[224:239], v[56:59], v[92:95], v[224:239]
    ds_read_b64_tr_b16 v[46:47], v27 offset:46080
    s_add_u32 m0, s78, 101376
    s_add_u32 s79, s71, 1462272
    buffer_load_dwordx4 v10, s[24:27], s79 offen lds
    v_mfma_f32_32x32x16_bf16 v[240:255], v[60:63], v[92:95], v[240:255]
    v_lshlrev_b32 v30, 16, v51
    v_and_b32 v31, s63, v51
    v_add_f32 v7, v7, v30
    v_add_f32 v23, v23, v31
    s_waitcnt vmcnt(22) lgkmcnt(0)
    v_mfma_f32_32x32x16_bf16 v[128:143], v[32:35], v[112:115], v[128:143]
    ds_read_b64_tr_b16 v[48:49], v24 offset:47104
    ds_read_b64_tr_b16 v[50:51], v24 offset:48128
    s_add_u32 s80, s82, 20480
    s_add_u32 s81, s80, 32768
    buffer_load_dwordx4 v[64:67], v2, s[36:39], s80 offen offset:0 sc1
    v_mfma_f32_32x32x16_bf16 v[144:159], v[36:39], v[112:115], v[144:159]
    ds_read_b64_tr_b16 v[52:53], v25 offset:47104
    v_lshlrev_b32 v30, 16, v32
    v_and_b32 v31, s63, v32
    v_add_f32 v7, v7, v30
    v_mfma_f32_32x32x16_bf16 v[160:175], v[40:43], v[112:115], v[160:175]
    ds_read_b64_tr_b16 v[54:55], v25 offset:48128
    buffer_load_dwordx4 v[68:71], v2, s[36:39], s81 offen offset:0 sc1
    v_add_f32 v23, v23, v31
    v_lshlrev_b32 v30, 16, v33
    v_mfma_f32_32x32x16_bf16 v[176:191], v[44:47], v[112:115], v[176:191]
    ds_read_b64_tr_b16 v[56:57], v26 offset:47104
    v_and_b32 v31, s63, v33
    v_add_f32 v7, v7, v30
    v_add_f32 v23, v23, v31
    v_mfma_f32_32x32x16_bf16 v[192:207], v[32:35], v[116:119], v[192:207]
    ds_read_b64_tr_b16 v[58:59], v26 offset:48128
    buffer_load_dwordx4 a[24:27], v2, s[40:43], s84 offen offset:2048 sc1
    v_lshlrev_b32 v30, 16, v34
    v_and_b32 v31, s63, v34
    v_mfma_f32_32x32x16_bf16 v[208:223], v[36:39], v[116:119], v[208:223]
    ds_read_b64_tr_b16 v[60:61], v27 offset:47104
    v_add_f32 v7, v7, v30
    v_add_f32 v23, v23, v31
    v_lshlrev_b32 v30, 16, v35
    v_mfma_f32_32x32x16_bf16 v[224:239], v[40:43], v[116:119], v[224:239]
    ds_read_b64_tr_b16 v[62:63], v27 offset:48128
    buffer_load_dwordx4 a[28:31], v2, s[40:43], s84 offen offset:3072 sc1
    v_and_b32 v31, s63, v35
    v_add_f32 v7, v7, v30
    v_mfma_f32_32x32x16_bf16 v[240:255], v[44:47], v[116:119], v[240:255]
    v_add_f32 v23, v23, v31
    s_waitcnt vmcnt(22) lgkmcnt(0)
    v_mfma_f32_32x32x16_bf16 v[128:143], v[48:51], v[120:123], v[128:143]
    v_add_u32 v24, 65536, v24
    v_add_u32 v25, 65536, v25
    buffer_load_dwordx4 v[72:75], v2, s[36:39], s80 offen offset:1024 sc1
    v_lshlrev_b32 v30, 16, v48
    v_and_b32 v31, s63, v48
    v_mfma_f32_32x32x16_bf16 v[144:159], v[52:55], v[120:123], v[144:159]
    v_add_u32 v26, 65536, v26
    v_add_u32 v27, 65536, v27
    v_add_f32 v7, v7, v30
    v_add_f32 v23, v23, v31
    v_lshlrev_b32 v30, 16, v49
    v_mfma_f32_32x32x16_bf16 v[160:175], v[56:59], v[120:123], v[160:175]
    s_waitcnt vmcnt(21)
    s_barrier
    ds_read_b64_tr_b16 v[32:33], v24 offset:0
    buffer_load_dwordx4 v[76:79], v2, s[36:39], s81 offen offset:1024 sc1
    v_and_b32 v31, s63, v49
    v_add_f32 v7, v7, v30
    v_mfma_f32_32x32x16_bf16 v[176:191], v[60:63], v[120:123], v[176:191]
    ds_read_b64_tr_b16 v[34:35], v24 offset:1024
    ds_read_b64_tr_b16 v[36:37], v25 offset:0
    v_add_f32 v23, v23, v31
    v_lshlrev_b32 v30, 16, v50
    v_and_b32 v31, s63, v50
    v_mfma_f32_32x32x16_bf16 v[192:207], v[48:51], v[124:127], v[192:207]
    ds_read_b64_tr_b16 v[38:39], v25 offset:1024
    ds_read_b64_tr_b16 v[40:41], v26 offset:0
    s_add_u32 m0, s78, 114688
    s_add_u32 s79, s71, 1376256
    buffer_load_dwordx4 v11, s[28:31], s79 offen lds
    v_mfma_f32_32x32x16_bf16 v[208:223], v[52:55], v[124:127], v[208:223]
    ds_read_b64_tr_b16 v[42:43], v26 offset:1024
    ds_read_b64_tr_b16 v[44:45], v27 offset:0
    v_add_f32 v7, v7, v30
    v_add_f32 v23, v23, v31
    v_lshlrev_b32 v30, 16, v51
    v_mfma_f32_32x32x16_bf16 v[224:239], v[56:59], v[124:127], v[224:239]
    ds_read_b64_tr_b16 v[46:47], v27 offset:1024
    s_add_u32 m0, s78, 115712
    s_add_u32 s79, s71, 1404928
    buffer_load_dwordx4 v11, s[28:31], s79 offen lds
    v_and_b32 v31, s63, v51
    v_mfma_f32_32x32x16_bf16 v[240:255], v[60:63], v[124:127], v[240:255]
    v_add_f32 v7, v7, v30
    v_add_f32 v23, v23, v31
    s_waitcnt vmcnt(22) lgkmcnt(0)
    v_mfma_f32_32x32x16_bf16 v[128:143], v[32:35], a[224:227], v[128:143]
    ds_read_b64_tr_b16 v[48:49], v24 offset:2048
    ds_read_b64_tr_b16 v[50:51], v24 offset:3072
    buffer_load_dwordx4 v[80:83], v2, s[36:39], s80 offen offset:2048 sc1
    v_lshlrev_b32 v30, 16, v32
    v_and_b32 v31, s63, v32
    v_mfma_f32_32x32x16_bf16 v[144:159], v[36:39], a[224:227], v[144:159]
    ds_read_b64_tr_b16 v[52:53], v25 offset:2048
    v_add_f32 v7, v7, v30
    v_add_f32 v23, v23, v31
    v_lshlrev_b32 v30, 16, v33
    v_and_b32 v31, s63, v33
    v_mfma_f32_32x32x16_bf16 v[160:175], v[40:43], a[224:227], v[160:175]
    ds_read_b64_tr_b16 v[54:55], v25 offset:3072
    buffer_load_dwordx4 v[84:87], v2, s[36:39], s81 offen offset:2048 sc1
    v_add_f32 v7, v7, v30
    v_add_f32 v23, v23, v31
    v_lshlrev_b32 v30, 16, v34
    v_mfma_f32_32x32x16_bf16 v[176:191], v[44:47], a[224:227], v[176:191]
    ds_read_b64_tr_b16 v[56:57], v26 offset:2048
    v_and_b32 v31, s63, v34
    v_add_f32 v7, v7, v30
    v_add_f32 v23, v23, v31
    v_lshlrev_b32 v30, 16, v35
    v_mfma_f32_32x32x16_bf16 v[192:207], v[32:35], a[228:231], v[192:207]
    ds_read_b64_tr_b16 v[58:59], v26 offset:3072
    buffer_load_dwordx4 v[88:91], v2, s[36:39], s80 offen offset:3072 sc1
    v_and_b32 v31, s63, v35
    v_add_f32 v7, v7, v30
    v_add_f32 v23, v23, v31
    v_mfma_f32_32x32x16_bf16 v[208:223], v[36:39], a[228:231], v[208:223]
    ds_read_b64_tr_b16 v[60:61], v27 offset:2048
    v_lshrrev_b32 v28, 2, v1
    v_xor_b32 v28, v28, v1
    v_and_b32 v28, 4, v28
    v_mov_b32 v29, s62
    v_mfma_f32_32x32x16_bf16 v[224:239], v[40:43], a[228:231], v[224:239]
    ds_read_b64_tr_b16 v[62:63], v27 offset:3072
    buffer_load_dwordx4 v[92:95], v2, s[36:39], s81 offen offset:3072 sc1
    v_cmp_eq_u32 vcc, 0, v28
    s_nop 1
    v_cndmask_b32 v28, 0, v29, vcc
    v_accvgpr_write_b32 a196, v28
    v_mfma_f32_32x32x16_bf16 v[240:255], v[44:47], a[228:231], v[240:255]
    v_accvgpr_write_b32 a197, v28
    v_accvgpr_write_b32 a198, v28
    v_accvgpr_write_b32 a199, v28
    s_waitcnt vmcnt(22) lgkmcnt(0)
    s_nop 0
    v_mfma_f32_16x16x32_bf16 a[204:207], a[196:199], v[48:51], 0
    v_mfma_f32_32x32x16_bf16 v[128:143], v[48:51], a[232:235], v[128:143]
    ds_read_b64_tr_b16 v[32:33], v24 offset:4096
    ds_read_b64_tr_b16 v[34:35], v24 offset:5120
    s_add_u32 s80, s82, 24576
    s_add_u32 s81, s80, 32768
    buffer_load_dwordx4 v[112:115], v2, s[36:39], s80 offen offset:0 sc1
    v_mfma_f32_32x32x16_bf16 v[144:159], v[52:55], a[232:235], v[144:159]
    ds_read_b64_tr_b16 v[36:37], v25 offset:4096
    s_waitcnt vmcnt(9)
    v_accvgpr_read_b32 v12, a0
    v_accvgpr_read_b32 v13, a1
    v_mfma_f32_32x32x16_bf16 v[160:175], v[56:59], a[232:235], v[160:175]
    ds_read_b64_tr_b16 v[38:39], v25 offset:5120
    buffer_load_dwordx4 v[116:119], v2, s[36:39], s81 offen offset:0 sc1
    v_accvgpr_read_b32 v14, a2
    v_accvgpr_read_b32 v15, a3
    v_mfma_f32_32x32x16_bf16 v[176:191], v[60:63], a[232:235], v[176:191]
    ds_read_b64_tr_b16 v[40:41], v26 offset:4096
    v_accvgpr_read_b32 v28, a4
    v_add_f32 v12, v12, v28
    v_accvgpr_read_b32 v28, a5
    v_mfma_f32_32x32x16_bf16 v[192:207], v[48:51], a[236:239], v[192:207]
    ds_read_b64_tr_b16 v[42:43], v26 offset:5120
    s_add_u32 m0, s78, 116736
    s_add_u32 s79, s71, 1433600
    buffer_load_dwordx4 v11, s[28:31], s79 offen lds
    v_mfma_f32_32x32x16_bf16 v[208:223], v[52:55], a[236:239], v[208:223]
    ds_read_b64_tr_b16 v[44:45], v27 offset:4096
    v_add_f32 v13, v13, v28
    v_accvgpr_read_b32 v28, a6
    v_add_f32 v14, v14, v28
    v_mfma_f32_32x32x16_bf16 v[224:239], v[56:59], a[236:239], v[224:239]
    ds_read_b64_tr_b16 v[46:47], v27 offset:5120
    s_add_u32 m0, s78, 117760
    s_add_u32 s79, s71, 1462272
    buffer_load_dwordx4 v11, s[28:31], s79 offen lds
    v_mfma_f32_32x32x16_bf16 v[240:255], v[60:63], a[236:239], v[240:255]
    v_accvgpr_read_b32 v28, a7
    v_add_f32 v15, v15, v28
    s_waitcnt lgkmcnt(0)
    v_mfma_f32_16x16x32_bf16 a[204:207], a[196:199], v[32:35], a[204:207]
    v_mfma_f32_32x32x16_bf16 v[128:143], v[32:35], a[240:243], v[128:143]
    ds_read_b64_tr_b16 v[48:49], v24 offset:6144
    ds_read_b64_tr_b16 v[50:51], v24 offset:7168
    buffer_load_dwordx4 v[120:123], v2, s[36:39], s80 offen offset:1024 sc1
    v_accvgpr_read_b32 v28, a8
    v_mfma_f32_32x32x16_bf16 v[144:159], v[36:39], a[240:243], v[144:159]
    ds_read_b64_tr_b16 v[52:53], v25 offset:6144
    v_add_f32 v12, v12, v28
    v_accvgpr_read_b32 v28, a9
    v_add_f32 v13, v13, v28
    v_mfma_f32_32x32x16_bf16 v[160:175], v[40:43], a[240:243], v[160:175]
    ds_read_b64_tr_b16 v[54:55], v25 offset:7168
    buffer_load_dwordx4 v[124:127], v2, s[36:39], s81 offen offset:1024 sc1
    v_accvgpr_read_b32 v28, a10
    v_add_f32 v14, v14, v28
    v_mfma_f32_32x32x16_bf16 v[176:191], v[44:47], a[240:243], v[176:191]
    ds_read_b64_tr_b16 v[56:57], v26 offset:6144
    v_accvgpr_read_b32 v28, a11
    v_add_f32 v15, v15, v28
    v_accvgpr_read_b32 v28, a12
    v_mfma_f32_32x32x16_bf16 v[192:207], v[32:35], a[244:247], v[192:207]
    ds_read_b64_tr_b16 v[58:59], v26 offset:7168
    buffer_load_dwordx4 a[224:227], v2, s[36:39], s80 offen offset:2048 sc1
    v_add_f32 v12, v12, v28
    v_accvgpr_read_b32 v28, a13
    v_mfma_f32_32x32x16_bf16 v[208:223], v[36:39], a[244:247], v[208:223]
    ds_read_b64_tr_b16 v[60:61], v27 offset:6144
    v_add_f32 v13, v13, v28
    v_accvgpr_read_b32 v28, a14
    v_add_f32 v14, v14, v28
    v_mfma_f32_32x32x16_bf16 v[224:239], v[40:43], a[244:247], v[224:239]
    ds_read_b64_tr_b16 v[62:63], v27 offset:7168
    buffer_load_dwordx4 a[228:231], v2, s[36:39], s81 offen offset:2048 sc1
    v_accvgpr_read_b32 v28, a15
    v_add_f32 v15, v15, v28
    v_mfma_f32_32x32x16_bf16 v[240:255], v[44:47], a[244:247], v[240:255]
    s_waitcnt lgkmcnt(0)
    v_mfma_f32_16x16x32_bf16 a[204:207], a[196:199], v[48:51], a[204:207]
    v_mfma_f32_32x32x16_bf16 v[128:143], v[48:51], a[248:251], v[128:143]
    ds_read_b64_tr_b16 v[32:33], v24 offset:8192
    ds_read_b64_tr_b16 v[34:35], v24 offset:9216
    buffer_load_dwordx4 a[232:235], v2, s[36:39], s80 offen offset:3072 sc1
    v_accvgpr_read_b32 v28, a16
    v_mfma_f32_32x32x16_bf16 v[144:159], v[52:55], a[248:251], v[144:159]
    ds_read_b64_tr_b16 v[36:37], v25 offset:8192
    v_add_f32 v12, v12, v28
    v_accvgpr_read_b32 v28, a17
    v_add_f32 v13, v13, v28
    v_mfma_f32_32x32x16_bf16 v[160:175], v[56:59], a[248:251], v[160:175]
    ds_read_b64_tr_b16 v[38:39], v25 offset:9216
    buffer_load_dwordx4 a[236:239], v2, s[36:39], s81 offen offset:3072 sc1
    v_accvgpr_read_b32 v28, a18
    v_add_f32 v14, v14, v28
    v_mfma_f32_32x32x16_bf16 v[176:191], v[60:63], a[248:251], v[176:191]
    ds_read_b64_tr_b16 v[40:41], v26 offset:8192
    v_accvgpr_read_b32 v28, a19
    v_add_f32 v15, v15, v28
    v_accvgpr_read_b32 v28, a20
    v_mfma_f32_32x32x16_bf16 v[192:207], v[48:51], a[252:255], v[192:207]
    ds_read_b64_tr_b16 v[42:43], v26 offset:9216
    s_add_u32 m0, s98, 139264
    s_add_u32 s76, s94, 65536
    buffer_load_dwordx4 v3, s[32:35], s76 offen lds
    v_mfma_f32_32x32x16_bf16 v[208:223], v[52:55], a[252:255], v[208:223]
    ds_read_b64_tr_b16 v[44:45], v27 offset:8192
    v_add_f32 v12, v12, v28
    v_accvgpr_read_b32 v28, a21
    v_add_f32 v13, v13, v28
    v_mfma_f32_32x32x16_bf16 v[224:239], v[56:59], a[252:255], v[224:239]
    ds_read_b64_tr_b16 v[46:47], v27 offset:9216
    buffer_load_dwordx4 v4, s[32:35], s76 offen offset:1024 lds
    v_accvgpr_read_b32 v28, a22
    v_add_f32 v14, v14, v28
    v_mfma_f32_32x32x16_bf16 v[240:255], v[60:63], a[252:255], v[240:255]
    v_accvgpr_read_b32 v28, a23
    v_add_f32 v15, v15, v28
    s_waitcnt lgkmcnt(0)
    v_mfma_f32_16x16x32_bf16 a[204:207], a[196:199], v[32:35], a[204:207]
    v_mfma_f32_32x32x16_bf16 v[128:143], v[32:35], v[64:67], v[128:143]
    ds_read_b64_tr_b16 v[48:49], v24 offset:10240
    ds_read_b64_tr_b16 v[50:51], v24 offset:11264
    s_add_u32 s80, s82, 28672
    s_add_u32 s81, s80, 32768
    buffer_load_dwordx4 a[240:243], v2, s[36:39], s80 offen offset:0 sc1
    v_mfma_f32_32x32x16_bf16 v[144:159], v[36:39], v[64:67], v[144:159]
    ds_read_b64_tr_b16 v[52:53], v25 offset:10240
    v_accvgpr_read_b32 v28, a24
    v_add_f32 v12, v12, v28
    v_accvgpr_read_b32 v28, a25
    v_mfma_f32_32x32x16_bf16 v[160:175], v[40:43], v[64:67], v[160:175]
    ds_read_b64_tr_b16 v[54:55], v25 offset:11264
    buffer_load_dwordx4 a[244:247], v2, s[36:39], s81 offen offset:0 sc1
    v_add_f32 v13, v13, v28
    v_accvgpr_read_b32 v28, a26
    v_mfma_f32_32x32x16_bf16 v[176:191], v[44:47], v[64:67], v[176:191]
    ds_read_b64_tr_b16 v[56:57], v26 offset:10240
    v_add_f32 v14, v14, v28
    v_accvgpr_read_b32 v28, a27
    v_add_f32 v15, v15, v28
    v_mfma_f32_32x32x16_bf16 v[192:207], v[32:35], v[68:71], v[192:207]
    ds_read_b64_tr_b16 v[58:59], v26 offset:11264
    s_add_u32 m0, s98, 141312
    s_add_u32 s76, s94, 81920
    buffer_load_dwordx4 v3, s[32:35], s76 offen lds
    v_mfma_f32_32x32x16_bf16 v[208:223], v[36:39], v[68:71], v[208:223]
    ds_read_b64_tr_b16 v[60:61], v27 offset:10240
    v_accvgpr_read_b32 v28, a28
    v_add_f32 v12, v12, v28
    v_accvgpr_read_b32 v28, a29
    v_mfma_f32_32x32x16_bf16 v[224:239], v[40:43], v[68:71], v[224:239]
    ds_read_b64_tr_b16 v[62:63], v27 offset:11264
    buffer_load_dwordx4 v4, s[32:35], s76 offen offset:1024 lds
    v_add_f32 v13, v13, v28
    v_accvgpr_read_b32 v28, a30
    v_mfma_f32_32x32x16_bf16 v[240:255], v[44:47], v[68:71], v[240:255]
    v_add_f32 v14, v14, v28
    v_accvgpr_read_b32 v28, a31
    v_add_f32 v15, v15, v28
    s_waitcnt vmcnt(22) lgkmcnt(0)
    v_mfma_f32_16x16x32_bf16 a[204:207], a[196:199], v[48:51], a[204:207]
    v_mfma_f32_32x32x16_bf16 v[128:143], v[48:51], v[72:75], v[128:143]
    s_waitcnt vmcnt(12)
    s_barrier
    ds_read_b64_tr_b16 v[32:33], v24 offset:12288
    buffer_load_dwordx4 a[248:251], v2, s[36:39], s80 offen offset:1024 sc1
    v_permlane32_swap_b32 v14, v15
    v_add_f32 v14, v14, v15
    v_mfma_f32_32x32x16_bf16 v[144:159], v[52:55], v[72:75], v[144:159]
    ds_read_b64_tr_b16 v[34:35], v24 offset:13312
    v_mov_b32 v15, v14
    s_nop 1
    v_permlane32_swap_b32 v14, v15
    v_mul_f32 v28, 0x3b000000, v14
    v_mul_f32 v15, 0x3b000000, v15
    v_mfma_f32_32x32x16_bf16 v[160:175], v[56:59], v[72:75], v[160:175]
    ds_read_b64_tr_b16 v[36:37], v25 offset:12288
    buffer_load_dwordx4 a[252:255], v2, s[36:39], s81 offen offset:1024 sc1
    v_fma_f32 v15, -v28, v28, v15
    v_max_f32 v15, 0, v15
    v_add_f32 v15, 0x3727c5ac, v15
    v_mfma_f32_32x32x16_bf16 v[176:191], v[60:63], v[72:75], v[176:191]
    ds_read_b64_tr_b16 v[38:39], v25 offset:13312
    ds_read_b64_tr_b16 v[40:41], v26 offset:12288
    v_rsq_f32 v29, v15
    s_nop 0
    v_mul_f32 v22, v29, v29
    v_cndmask_b32 v29, -v28, 0, s[60:61]
    v_mfma_f32_32x32x16_bf16 v[192:207], v[48:51], v[76:79], v[192:207]
    ds_read_b64_tr_b16 v[42:43], v26 offset:13312
    s_add_u32 m0, s98, 143360
    s_add_u32 s76, s94, 98304
    buffer_load_dwordx4 v3, s[32:35], s76 offen lds
    v_cvt_pk_bf16_f32 v8, v29, v29
    v_mfma_f32_32x32x16_bf16 v[208:223], v[52:55], v[76:79], v[208:223]
    ds_read_b64_tr_b16 v[44:45], v27 offset:12288
    v_and_b32 v9, s63, v8
    v_sub_f32 v29, v29, v9
    v_cvt_pk_bf16_f32 v9, v29, 0
    v_mov_b32 v10, 0
    v_mfma_f32_32x32x16_bf16 v[224:239], v[56:59], v[76:79], v[224:239]
    ds_read_b64_tr_b16 v[46:47], v27 offset:13312
    buffer_load_dwordx4 v4, s[32:35], s76 offen offset:1024 lds
    v_mov_b32 v11, 0
    v_mfma_f32_32x32x16_bf16 v[240:255], v[60:63], v[76:79], v[240:255]
    s_waitcnt lgkmcnt(0)
    v_mfma_f32_16x16x32_bf16 a[204:207], a[196:199], v[32:35], a[204:207]
    v_mfma_f32_32x32x16_bf16 v[128:143], v[32:35], v[80:83], v[128:143]
    ds_read_b64_tr_b16 v[48:49], v24 offset:14336
    ds_read_b64_tr_b16 v[50:51], v24 offset:15360
    ds_read_b64_tr_b16 v[52:53], v25 offset:14336
    ds_read_b64_tr_b16 v[54:55], v25 offset:15360
    buffer_load_dwordx4 v[64:67], v2, s[36:39], s80 offen offset:2048 sc1
    v_permlane32_swap_b32 v12, v13
    v_mfma_f32_32x32x16_bf16 v[144:159], v[36:39], v[80:83], v[144:159]
    ds_read_b64_tr_b16 v[56:57], v26 offset:14336
    ds_read_b64_tr_b16 v[58:59], v26 offset:15360
    ds_read_b64_tr_b16 v[60:61], v27 offset:14336
    v_add_f32 v12, v12, v13
    v_mov_b32 v13, v12
    s_nop 1
    v_permlane32_swap_b32 v12, v13
    v_mfma_f32_32x32x16_bf16 v[160:175], v[40:43], v[80:83], v[160:175]
    ds_read_b64_tr_b16 v[62:63], v27 offset:15360
    ds_read_b64_tr_b16 a[184:185], v24 offset:32768
    ds_read_b64_tr_b16 a[186:187], v24 offset:33792
    ds_read_b64_tr_b16 a[188:189], v24 offset:34816
    buffer_load_dwordx4 v[68:71], v2, s[36:39], s81 offen offset:2048 sc1
    v_mul_f32 v28, 0x3b000000, v12
    v_mfma_f32_32x32x16_bf16 v[176:191], v[44:47], v[80:83], v[176:191]
    ds_read_b64_tr_b16 a[190:191], v24 offset:35840
    ds_read_b64_tr_b16 a[192:193], v24 offset:36864
    ds_read_b64_tr_b16 a[194:195], v24 offset:37888
    v_mul_f32 v13, 0x3b000000, v13
    v_fma_f32 v13, -v28, v28, v13
    v_max_f32 v13, 0, v13
    v_mfma_f32_32x32x16_bf16 v[192:207], v[32:35], v[84:87], v[192:207]
    ds_read_b64_tr_b16 a[104:105], v24 offset:38912
    ds_read_b64_tr_b16 a[106:107], v24 offset:39936
    ds_read_b64_tr_b16 a[120:121], v24 offset:40960
    ds_read_b64_tr_b16 a[122:123], v24 offset:41984
    s_add_u32 m0, s67, 0
    s_add_u32 s76, s94, 114688
    buffer_load_dwordx4 v3, s[32:35], s76 offen lds
    v_mfma_f32_32x32x16_bf16 v[208:223], v[36:39], v[84:87], v[208:223]
    ds_read_b64_tr_b16 a[136:137], v24 offset:43008
    ds_read_b64_tr_b16 a[138:139], v24 offset:44032
    ds_read_b64_tr_b16 a[152:153], v24 offset:45056
    v_add_f32 v13, 0x3727c5ac, v13
    v_rsq_f32 v29, v13
    s_nop 0
    v_mul_f32 v16, v29, v29
    v_mfma_f32_32x32x16_bf16 v[224:239], v[40:43], v[84:87], v[224:239]
    ds_read_b64_tr_b16 a[154:155], v24 offset:46080
    ds_read_b64_tr_b16 a[168:169], v24 offset:47104
    ds_read_b64_tr_b16 a[170:171], v24 offset:48128
    buffer_load_dwordx4 v4, s[32:35], s76 offen offset:1024 lds
    v_cndmask_b32 v29, -v28, 0, s[60:61]
    v_cvt_pk_bf16_f32 v12, v29, v29
    v_mfma_f32_32x32x16_bf16 v[240:255], v[44:47], v[84:87], v[240:255]
    v_and_b32 v13, s63, v12
    v_sub_f32 v29, v29, v13
    v_cvt_pk_bf16_f32 v13, v29, 0
    v_mov_b32 v14, 0
    v_mov_b32 v15, 0
    s_waitcnt lgkmcnt(0)
    v_mfma_f32_16x16x32_bf16 a[204:207], a[196:199], v[48:51], a[204:207]
    v_mfma_f32_32x32x16_bf16 v[128:143], v[48:51], v[88:91], v[128:143]
    v_mfma_f32_16x16x32_bf16 a[204:207], a[196:199], a[184:187], a[204:207]
    s_barrier
    ds_read_b64_tr_b16 v[32:33], v24 offset:32768
    ds_read_b64_tr_b16 v[34:35], v24 offset:33792
    buffer_load_dwordx4 v[72:75], v2, s[36:39], s80 offen offset:3072 sc1
    v_add_f32 v7, v7, v23
    v_mfma_f32_32x32x16_bf16 v[144:159], v[52:55], v[88:91], v[144:159]
    v_mfma_f32_16x16x32_bf16 a[204:207], a[196:199], a[188:191], a[204:207]
    ds_read_b64_tr_b16 v[36:37], v25 offset:32768
    ds_read_b64_tr_b16 v[38:39], v25 offset:33792
    ds_read_b64_tr_b16 v[40:41], v26 offset:32768
    v_mov_b32 v23, v7
    v_and_b32 v30, 31, v1
    v_mfma_f32_32x32x16_bf16 v[160:175], v[56:59], v[88:91], v[160:175]
    v_mfma_f32_16x16x32_bf16 a[204:207], a[196:199], a[192:195], a[204:207]
    ds_read_b64_tr_b16 v[42:43], v26 offset:33792
    ds_read_b64_tr_b16 v[44:45], v27 offset:32768
    ds_read_b64_tr_b16 v[46:47], v27 offset:33792
    buffer_load_dwordx4 v[76:79], v2, s[36:39], s81 offen offset:3072 sc1
    v_lshlrev_b32 v30, 2, v30
    v_mfma_f32_32x32x16_bf16 v[176:191], v[60:63], v[88:91], v[176:191]
    v_mfma_f32_16x16x32_bf16 a[204:207], a[196:199], a[104:107], a[204:207]
    ds_read_b64_tr_b16 a[108:109], v25 offset:38912
    ds_read_b64_tr_b16 a[110:111], v25 offset:39936
    v_add_u32 v30, 131072, v30
    v_permlane32_swap_b32 v7, v23
    s_lshl_b32 s72, s48, 7
    v_mfma_f32_32x32x16_bf16 v[192:207], v[48:51], v[92:95], v[192:207]
    v_mfma_f32_16x16x32_bf16 a[204:207], a[196:199], a[120:123], a[204:207]
    ds_read_b64_tr_b16 a[112:113], v26 offset:38912
    ds_read_b64_tr_b16 a[114:115], v26 offset:39936
    ds_read_b64_tr_b16 a[116:117], v27 offset:38912
    s_add_u32 m0, s67, 2048
    s_add_u32 s76, s94, 131072
    buffer_load_dwordx4 v3, s[32:35], s76 offen lds
    v_mfma_f32_32x32x16_bf16 v[208:223], v[52:55], v[92:95], v[208:223]
    v_mfma_f32_16x16x32_bf16 a[204:207], a[196:199], a[136:139], a[204:207]
    ds_read_b64_tr_b16 a[118:119], v27 offset:39936
    ds_read_b64_tr_b16 a[124:125], v25 offset:40960
    ds_read_b64_tr_b16 a[126:127], v25 offset:41984
    v_add_u32 v31, s72, v30
    v_add_f32 v7, v7, v23
    v_mfma_f32_32x32x16_bf16 v[224:239], v[56:59], v[92:95], v[224:239]
    v_mfma_f32_16x16x32_bf16 a[204:207], a[196:199], a[152:155], a[204:207]
    ds_read_b64_tr_b16 a[128:129], v26 offset:40960
    ds_read_b64_tr_b16 a[130:131], v26 offset:41984
    buffer_load_dwordx4 v4, s[32:35], s76 offen offset:1024 lds
    v_mfma_f32_32x32x16_bf16 v[240:255], v[60:63], v[92:95], v[240:255]
    v_mfma_f32_16x16x32_bf16 a[204:207], a[196:199], a[168:171], a[204:207]
    s_waitcnt lgkmcnt(10)
    v_mfma_f32_32x32x16_bf16 v[128:143], v[32:35], v[112:115], v[128:143]
    s_nop 5
    v_accvgpr_read_b32 v28, a204
    v_add_f32 v7, v7, v28
    ds_write_b32 v31, v7
    s_lshl_b32 s73, s48, 8
    v_add_u32 v28, s73, v30
    ds_write_b32 v28, v16 offset:512
    s_add_u32 m0, s67, 4096
    s_add_u32 s76, s94, 147456
    buffer_load_dwordx4 v3, s[32:35], s76 offen lds
    v_mfma_f32_32x32x16_bf16 v[144:159], v[36:39], v[112:115], v[144:159]
    ds_write_b32 v28, v22 offset:640
    ds_read_b64_tr_b16 v[48:49], v24 offset:34816
    ds_read_b64_tr_b16 v[50:51], v24 offset:35840
    ds_read_b64_tr_b16 v[52:53], v25 offset:34816
    ds_read_b64_tr_b16 v[54:55], v25 offset:35840
    ds_read_b64_tr_b16 v[56:57], v26 offset:34816
    v_mfma_f32_32x32x16_bf16 v[160:175], v[40:43], v[112:115], v[160:175]
    ds_read_b64_tr_b16 v[58:59], v26 offset:35840
    ds_read_b64_tr_b16 v[60:61], v27 offset:34816
    ds_read_b64_tr_b16 v[62:63], v27 offset:35840
    ds_read_b64_tr_b16 a[132:133], v27 offset:40960
    ds_read_b64_tr_b16 a[134:135], v27 offset:41984
    ds_read_b64_tr_b16 a[140:141], v25 offset:43008
    buffer_load_dwordx4 v4, s[32:35], s76 offen offset:1024 lds
    v_mfma_f32_32x32x16_bf16 v[176:191], v[44:47], v[112:115], v[176:191]
    ds_read_b64_tr_b16 a[142:143], v25 offset:44032
    ds_read_b64_tr_b16 a[144:145], v26 offset:43008
    ds_read_b64_tr_b16 a[146:147], v26 offset:44032
    ds_read_b64_tr_b16 a[148:149], v27 offset:43008
    ds_read_b64_tr_b16 a[150:151], v27 offset:44032
    ds_read_b64_tr_b16 a[156:157], v25 offset:45056
    v_mfma_f32_32x32x16_bf16 v[192:207], v[32:35], v[116:119], v[192:207]
    ds_read_b64_tr_b16 a[158:159], v25 offset:46080
    s_waitcnt lgkmcnt(15)
    s_barrier
    s_xor_b32 s72, s48, 0
    s_lshl_b32 s72, s72, 7
    v_add_u32 v31, s72, v30
    ds_read_b32 v80, v31
    s_add_u32 m0, s67, 6144
    s_add_u32 s76, s94, 163840
    buffer_load_dwordx4 v3, s[32:35], s76 offen lds
    v_mfma_f32_32x32x16_bf16 v[208:223], v[36:39], v[116:119], v[208:223]
    s_xor_b32 s72, s48, 1
    s_lshl_b32 s72, s72, 7
    v_add_u32 v31, s72, v30
    ds_read_b32 v81, v31
    s_xor_b32 s72, s48, 2
    s_lshl_b32 s72, s72, 7
    v_mfma_f32_32x32x16_bf16 v[224:239], v[40:43], v[116:119], v[224:239]
    v_add_u32 v31, s72, v30
    ds_read_b32 v82, v31
    s_xor_b32 s72, s48, 3
    s_lshl_b32 s72, s72, 7
    v_add_u32 v31, s72, v30
    ds_read_b32 v83, v31
    buffer_load_dwordx4 v4, s[32:35], s76 offen offset:1024 lds
    v_mfma_f32_32x32x16_bf16 v[240:255], v[44:47], v[116:119], v[240:255]
    s_waitcnt vmcnt(26) lgkmcnt(14)
    v_mfma_f32_32x32x16_bf16 v[128:143], v[48:51], v[120:123], v[128:143]
    ds_read_b64_tr_b16 v[32:33], v24 offset:36864
    ds_read_b64_tr_b16 v[34:35], v24 offset:37888
    ds_read_b64_tr_b16 v[36:37], v25 offset:36864
    s_add_u32 m0, s67, 32768
    s_add_u32 s76, s94, 180224
    buffer_load_dwordx4 v3, s[32:35], s76 offen lds
    s_waitcnt lgkmcnt(6)
    v_cvt_pk_bf16_f32 v29, v80, 0
    v_accvgpr_write_b32 a210, 0
    v_mfma_f32_32x32x16_bf16 v[144:159], v[52:55], v[120:123], v[144:159]
    ds_read_b64_tr_b16 v[38:39], v25 offset:37888
    ds_read_b64_tr_b16 v[40:41], v26 offset:36864
    ds_read_b64_tr_b16 v[42:43], v26 offset:37888
    v_lshlrev_b32 v28, 16, v29
    v_accvgpr_write_b32 a209, v29
    v_sub_f32 v28, v80, v28
    v_accvgpr_write_b32 a211, 0
    v_cvt_pk_bf16_f32 v28, v80, v28
    v_accvgpr_write_b32 a208, v28
    v_mfma_f32_32x32x16_bf16 v[160:175], v[56:59], v[120:123], v[160:175]
    ds_read_b64_tr_b16 v[44:45], v27 offset:36864
    ds_read_b64_tr_b16 v[46:47], v27 offset:37888
    buffer_load_dwordx4 v4, s[32:35], s76 offen offset:1024 lds
    s_waitcnt lgkmcnt(10)
    v_cvt_pk_bf16_f32 v29, v81, 0
    v_accvgpr_write_b32 a214, 0
    v_lshlrev_b32 v28, 16, v29
    v_accvgpr_write_b32 a213, v29
    v_sub_f32 v28, v81, v28
    v_mfma_f32_32x32x16_bf16 v[176:191], v[60:63], v[120:123], v[176:191]
    ds_read_b64_tr_b16 a[160:161], v26 offset:45056
    ds_read_b64_tr_b16 a[162:163], v26 offset:46080
    ds_read_b64_tr_b16 a[164:165], v27 offset:45056
    v_accvgpr_write_b32 a215, 0
    v_cvt_pk_bf16_f32 v28, v81, v28
    v_accvgpr_write_b32 a212, v28
    s_waitcnt lgkmcnt(12)
    v_cvt_pk_bf16_f32 v29, v82, 0
    v_accvgpr_write_b32 a218, 0
    v_mfma_f32_32x32x16_bf16 v[192:207], v[48:51], v[124:127], v[192:207]
    ds_read_b64_tr_b16 a[166:167], v27 offset:46080
    ds_read_b64_tr_b16 a[172:173], v25 offset:47104
    s_add_u32 m0, s67, 34816
    s_add_u32 s76, s94, 196608
    buffer_load_dwordx4 v3, s[32:35], s76 offen lds
    v_lshlrev_b32 v28, 16, v29
    v_accvgpr_write_b32 a217, v29
    v_sub_f32 v28, v82, v28
    v_accvgpr_write_b32 a219, 0
    v_mfma_f32_32x32x16_bf16 v[208:223], v[52:55], v[124:127], v[208:223]
    ds_read_b64_tr_b16 a[174:175], v25 offset:48128
    ds_read_b64_tr_b16 a[176:177], v26 offset:47104
    ds_read_b64_tr_b16 a[178:179], v26 offset:48128
    v_cvt_pk_bf16_f32 v28, v82, v28
    v_accvgpr_write_b32 a216, v28
    s_waitcnt lgkmcnt(15)
    v_cvt_pk_bf16_f32 v29, v83, 0
    v_accvgpr_write_b32 a222, 0
    v_lshlrev_b32 v28, 16, v29
    v_mfma_f32_32x32x16_bf16 v[224:239], v[56:59], v[124:127], v[224:239]
    ds_read_b64_tr_b16 a[180:181], v27 offset:47104
    ds_read_b64_tr_b16 a[182:183], v27 offset:48128
    buffer_load_dwordx4 v4, s[32:35], s76 offen offset:1024 lds
    v_accvgpr_write_b32 a221, v29
    v_sub_f32 v28, v83, v28
    v_accvgpr_write_b32 a223, 0
    v_cvt_pk_bf16_f32 v28, v83, v28
    v_accvgpr_write_b32 a220, v28
    s_mul_i32 s74, s48, 224
    v_mfma_f32_32x32x16_bf16 v[240:255], v[60:63], v[124:127], v[240:255]
    s_lshl2_add_u32 s74, s68, s74
    s_lshl_b32 s74, s74, 10
    s_add_u32 s74, s74, s97
    v_mov_b32 v7, v2
    s_waitcnt vmcnt(10) lgkmcnt(0)
    s_barrier
    v_mfma_f32_32x32x16_bf16 v[128:143], v[32:35], a[224:227], v[128:143]
    s_add_u32 m0, s67, 36864
    s_add_u32 s76, s94, 212992
    buffer_load_dwordx4 v3, s[32:35], s76 offen lds
    ds_read_b64_tr_b16 a[32:33], v5 offset:0
    ds_read_b64_tr_b16 a[34:35], v5 offset:1024
    ds_read_b64_tr_b16 a[36:37], v6 offset:0
    ds_read_b64_tr_b16 a[38:39], v6 offset:1024
    v_mfma_f32_32x32x16_bf16 v[128:143], a[104:107], a[232:235], v[128:143]
    v_mfma_f32_32x32x16_bf16 v[128:143], a[120:123], a[240:243], v[128:143]
    buffer_load_dwordx4 v4, s[32:35], s76 offen offset:1024 lds
    v_mfma_f32_32x32x16_bf16 v[128:143], a[136:139], a[248:251], v[128:143]
    v_mfma_f32_32x32x16_bf16 v[128:143], a[152:155], v[64:67], v[128:143]
    s_add_u32 m0, s67, 38912
    s_add_u32 s76, s94, 229376
    buffer_load_dwordx4 v3, s[32:35], s76 offen lds
    ds_read_b64_tr_b16 a[40:41], v5 offset:2048
    ds_read_b64_tr_b16 a[42:43], v5 offset:3072
    ds_read_b64_tr_b16 a[44:45], v6 offset:2048
    ds_read_b64_tr_b16 a[46:47], v6 offset:3072
    v_mfma_f32_32x32x16_bf16 v[128:143], a[168:171], v[72:75], v[128:143]
    v_mfma_f32_32x32x16_bf16 v[128:143], a[208:211], v[12:15], v[128:143]
    buffer_load_dwordx4 v4, s[32:35], s76 offen offset:1024 lds
    s_nop 1
    v_mfma_f32_32x32x16_bf16 v[192:207], v[32:35], a[228:231], v[192:207]
    s_nop 2
    v_mfma_f32_32x32x16_bf16 v[192:207], a[104:107], a[236:239], v[192:207]
    s_add_u32 m0, s67, 65536
    s_add_u32 s76, s94, 245760
    buffer_load_dwordx4 v3, s[32:35], s76 offen lds
    ds_read_b64_tr_b16 a[48:49], v5 offset:4096
    ds_read_b64_tr_b16 a[50:51], v5 offset:5120
    ds_read_b64_tr_b16 a[52:53], v6 offset:4096
    ds_read_b64_tr_b16 a[54:55], v6 offset:5120
    v_mfma_f32_32x32x16_bf16 v[192:207], a[120:123], a[244:247], v[192:207]
    s_xor_b32 s72, s48, 0
    s_lshl_b32 s72, s72, 10
    s_add_u32 s72, s72, s74
    s_add_u32 s73, s72, 114688
    v_mul_f32 v128, v128, v136
    v_mfma_f32_32x32x16_bf16 v[192:207], a[136:139], a[252:255], v[192:207]
    buffer_load_dwordx4 v4, s[32:35], s76 offen offset:1024 lds
    v_mul_f32 v129, v129, v137
    v_mul_f32 v130, v130, v138
    v_mul_f32 v131, v131, v139
    v_mul_f32 v132, v132, v140
    v_mfma_f32_32x32x16_bf16 v[192:207], a[152:155], v[68:71], v[192:207]
    v_mul_f32 v133, v133, v141
    v_mul_f32 v134, v134, v142
    v_mul_f32 v135, v135, v143
    v_cvt_pk_bf16_f32 v128, v128, v129
    v_mfma_f32_32x32x16_bf16 v[192:207], a[168:171], v[76:79], v[192:207]
    s_add_u32 m0, s67, 67584
    s_add_u32 s76, s94, 262144
    buffer_load_dwordx4 v3, s[32:35], s76 offen lds
    ds_read_b64_tr_b16 a[56:57], v18 offset:0
    ds_read_b64_tr_b16 a[58:59], v18 offset:1024
    ds_read_b64_tr_b16 a[60:61], v19 offset:0
    ds_read_b64_tr_b16 a[62:63], v19 offset:1024
    v_cvt_pk_bf16_f32 v129, v130, v131
    v_cvt_pk_bf16_f32 v130, v132, v133
    v_cvt_pk_bf16_f32 v131, v134, v135
    buffer_store_dwordx4 v[128:131], v7, s[40:43], s72 offen sc1
    v_mfma_f32_32x32x16_bf16 v[192:207], a[208:211], v[8:11], v[192:207]
    s_nop 2
    v_mfma_f32_32x32x16_bf16 v[144:159], v[36:39], a[224:227], v[144:159]
    buffer_load_dwordx4 v4, s[32:35], s76 offen offset:1024 lds
    s_nop 1
    v_mfma_f32_32x32x16_bf16 v[144:159], a[108:111], a[232:235], v[144:159]
    s_nop 2
    v_mfma_f32_32x32x16_bf16 v[144:159], a[124:127], a[240:243], v[144:159]
    s_add_u32 m0, s67, 69632
    s_add_u32 s76, s94, 278528
    buffer_load_dwordx4 v3, s[32:35], s76 offen lds
    s_waitcnt vmcnt(18)
    ds_read_b64_tr_b16 a[64:65], v18 offset:2048
    ds_read_b64_tr_b16 a[66:67], v18 offset:3072
    ds_read_b64_tr_b16 a[68:69], v19 offset:2048
    ds_read_b64_tr_b16 a[70:71], v19 offset:3072
    v_mul_f32 v192, v192, v200
    v_mul_f32 v193, v193, v201
    v_mul_f32 v194, v194, v202
    v_mul_f32 v195, v195, v203
    v_mfma_f32_32x32x16_bf16 v[144:159], a[140:143], a[248:251], v[144:159]
    v_mul_f32 v196, v196, v204
    v_mul_f32 v197, v197, v205
    v_mul_f32 v198, v198, v206
    v_mfma_f32_32x32x16_bf16 v[144:159], a[156:159], v[64:67], v[144:159]
    buffer_load_dwordx4 v4, s[32:35], s76 offen offset:1024 lds
    v_mul_f32 v199, v199, v207
    v_cvt_pk_bf16_f32 v192, v192, v193
    v_cvt_pk_bf16_f32 v193, v194, v195
    v_mfma_f32_32x32x16_bf16 v[144:159], a[172:175], v[72:75], v[144:159]
    v_cvt_pk_bf16_f32 v194, v196, v197
    v_cvt_pk_bf16_f32 v195, v198, v199
    buffer_store_dwordx4 v[192:195], v7, s[40:43], s73 offen sc1
    v_mfma_f32_32x32x16_bf16 v[144:159], a[212:215], v[12:15], v[144:159]
    s_add_u32 m0, s67, 71680
    s_add_u32 s76, s94, 294912
    buffer_load_dwordx4 v3, s[32:35], s76 offen lds
    s_waitcnt vmcnt(19)
    ds_read_b64_tr_b16 a[72:73], v18 offset:4096
    ds_read_b64_tr_b16 a[74:75], v18 offset:5120
    ds_read_b64_tr_b16 a[76:77], v19 offset:4096
    ds_read_b64_tr_b16 a[78:79], v19 offset:5120
    v_mfma_f32_32x32x16_bf16 v[208:223], v[36:39], a[228:231], v[208:223]
    s_nop 2
    v_mfma_f32_32x32x16_bf16 v[208:223], a[108:111], a[236:239], v[208:223]
    buffer_load_dwordx4 v4, s[32:35], s76 offen offset:1024 lds
    s_nop 1
    v_mfma_f32_32x32x16_bf16 v[208:223], a[124:127], a[244:247], v[208:223]
    s_xor_b32 s72, s48, 1
    s_lshl_b32 s72, s72, 10
    s_add_u32 s72, s72, s74
    s_add_u32 s73, s72, 114688
    v_mul_f32 v144, v144, v152
    v_mfma_f32_32x32x16_bf16 v[208:223], a[140:143], a[252:255], v[208:223]
    s_add_u32 m0, s67, 98304
    s_add_u32 s76, s94, 311296
    buffer_load_dwordx4 v3, s[32:35], s76 offen lds
    s_waitcnt vmcnt(19)
    ds_read_b64_tr_b16 a[80:81], v18 offset:6144
    ds_read_b64_tr_b16 a[82:83], v18 offset:7168
    ds_read_b64_tr_b16 a[84:85], v19 offset:6144
    ds_read_b64_tr_b16 a[86:87], v19 offset:7168
    v_mul_f32 v145, v145, v153
    v_mul_f32 v146, v146, v154
    v_mul_f32 v147, v147, v155
    v_mul_f32 v148, v148, v156
    v_mfma_f32_32x32x16_bf16 v[208:223], a[156:159], v[68:71], v[208:223]
    v_mul_f32 v149, v149, v157
    v_mul_f32 v150, v150, v158
    v_mul_f32 v151, v151, v159
    v_cvt_pk_bf16_f32 v144, v144, v145
    v_mfma_f32_32x32x16_bf16 v[208:223], a[172:175], v[76:79], v[208:223]
    buffer_load_dwordx4 v4, s[32:35], s76 offen offset:1024 lds
    v_cvt_pk_bf16_f32 v145, v146, v147
    v_cvt_pk_bf16_f32 v146, v148, v149
    v_cvt_pk_bf16_f32 v147, v150, v151
    buffer_store_dwordx4 v[144:147], v7, s[40:43], s72 offen sc1
    v_mfma_f32_32x32x16_bf16 v[208:223], a[212:215], v[8:11], v[208:223]
    s_nop 2
    v_mfma_f32_32x32x16_bf16 v[160:175], v[40:43], a[224:227], v[160:175]
    s_add_u32 m0, s67, 100352
    s_add_u32 s76, s94, 327680
    buffer_load_dwordx4 v3, s[32:35], s76 offen lds
    s_waitcnt vmcnt(20)
    ds_read_b64_tr_b16 a[88:89], v18 offset:32768
    ds_read_b64_tr_b16 a[90:91], v18 offset:33792
    ds_read_b64_tr_b16 a[92:93], v19 offset:32768
    ds_read_b64_tr_b16 a[94:95], v19 offset:33792
    v_mfma_f32_32x32x16_bf16 v[160:175], a[112:115], a[232:235], v[160:175]
    s_nop 2
    v_mfma_f32_32x32x16_bf16 v[160:175], a[128:131], a[240:243], v[160:175]
    buffer_load_dwordx4 v4, s[32:35], s76 offen offset:1024 lds
    v_mul_f32 v208, v208, v216
    v_mul_f32 v209, v209, v217
    v_mul_f32 v210, v210, v218
    v_mul_f32 v211, v211, v219
    v_mfma_f32_32x32x16_bf16 v[160:175], a[144:147], a[248:251], v[160:175]
    v_mul_f32 v212, v212, v220
    v_mul_f32 v213, v213, v221
    v_mul_f32 v214, v214, v222
    v_mfma_f32_32x32x16_bf16 v[160:175], a[160:163], v[64:67], v[160:175]
    s_waitcnt vmcnt(19)
    ds_read_b64_tr_b16 a[96:97], v18 offset:34816
    ds_read_b64_tr_b16 a[98:99], v18 offset:35840
    ds_read_b64_tr_b16 a[100:101], v19 offset:34816
    ds_read_b64_tr_b16 a[102:103], v19 offset:35840
    v_mul_f32 v215, v215, v223
    v_cvt_pk_bf16_f32 v208, v208, v209
    v_cvt_pk_bf16_f32 v209, v210, v211
    v_mfma_f32_32x32x16_bf16 v[160:175], a[176:179], v[72:75], v[160:175]
    v_cvt_pk_bf16_f32 v210, v212, v213
    v_cvt_pk_bf16_f32 v211, v214, v215
    buffer_store_dwordx4 v[208:211], v7, s[40:43], s73 offen sc1
    v_mfma_f32_32x32x16_bf16 v[160:175], a[216:219], v[12:15], v[160:175]
    s_nop 2
    v_mfma_f32_32x32x16_bf16 v[224:239], v[40:43], a[228:231], v[224:239]
    s_nop 2
    v_mfma_f32_32x32x16_bf16 v[224:239], a[112:115], a[236:239], v[224:239]
    s_nop 2
    v_mfma_f32_32x32x16_bf16 v[224:239], a[128:131], a[244:247], v[224:239]
    s_xor_b32 s72, s48, 2
    s_lshl_b32 s72, s72, 10
    s_add_u32 s72, s72, s74
    s_add_u32 s73, s72, 114688
    v_mul_f32 v160, v160, v168
    v_mfma_f32_32x32x16_bf16 v[224:239], a[144:147], a[252:255], v[224:239]
    v_mul_f32 v161, v161, v169
    v_mul_f32 v162, v162, v170
    v_mul_f32 v163, v163, v171
    v_mul_f32 v164, v164, v172
    v_mfma_f32_32x32x16_bf16 v[224:239], a[160:163], v[68:71], v[224:239]
    v_mul_f32 v165, v165, v173
    v_mul_f32 v166, v166, v174
    v_mul_f32 v167, v167, v175
    v_cvt_pk_bf16_f32 v160, v160, v161
    v_mfma_f32_32x32x16_bf16 v[224:239], a[176:179], v[76:79], v[224:239]
    v_cvt_pk_bf16_f32 v161, v162, v163
    v_cvt_pk_bf16_f32 v162, v164, v165
    v_cvt_pk_bf16_f32 v163, v166, v167
    buffer_store_dwordx4 v[160:163], v7, s[40:43], s72 offen sc1
    v_mfma_f32_32x32x16_bf16 v[224:239], a[216:219], v[8:11], v[224:239]
    s_nop 2
    v_mfma_f32_32x32x16_bf16 v[176:191], v[44:47], a[224:227], v[176:191]
    s_nop 2
    v_mfma_f32_32x32x16_bf16 v[176:191], a[116:119], a[232:235], v[176:191]
    s_nop 2
    v_mfma_f32_32x32x16_bf16 v[176:191], a[132:135], a[240:243], v[176:191]
    v_mul_f32 v224, v224, v232
    v_mul_f32 v225, v225, v233
    v_mul_f32 v226, v226, v234
    v_mul_f32 v227, v227, v235
    v_mfma_f32_32x32x16_bf16 v[176:191], a[148:151], a[248:251], v[176:191]
    v_mul_f32 v228, v228, v236
    v_mul_f32 v229, v229, v237
    v_mul_f32 v230, v230, v238
    v_mfma_f32_32x32x16_bf16 v[176:191], a[164:167], v[64:67], v[176:191]
    v_mul_f32 v231, v231, v239
    v_cvt_pk_bf16_f32 v224, v224, v225
    v_cvt_pk_bf16_f32 v225, v226, v227
    v_mfma_f32_32x32x16_bf16 v[176:191], a[180:183], v[72:75], v[176:191]
    v_cvt_pk_bf16_f32 v226, v228, v229
    v_cvt_pk_bf16_f32 v227, v230, v231
    buffer_store_dwordx4 v[224:227], v7, s[40:43], s73 offen sc1
    v_mfma_f32_32x32x16_bf16 v[176:191], a[220:223], v[12:15], v[176:191]
    s_nop 2
    v_mfma_f32_32x32x16_bf16 v[240:255], v[44:47], a[228:231], v[240:255]
    s_nop 2
    v_mfma_f32_32x32x16_bf16 v[240:255], a[116:119], a[236:239], v[240:255]
    s_nop 2
    v_mfma_f32_32x32x16_bf16 v[240:255], a[132:135], a[244:247], v[240:255]
    s_xor_b32 s72, s48, 3
    s_lshl_b32 s72, s72, 10
    s_add_u32 s72, s72, s74
    s_add_u32 s73, s72, 114688
    v_mul_f32 v176, v176, v184
    v_mfma_f32_32x32x16_bf16 v[240:255], a[148:151], a[252:255], v[240:255]
    v_mul_f32 v177, v177, v185
    v_mul_f32 v178, v178, v186
    v_mul_f32 v179, v179, v187
    v_mul_f32 v180, v180, v188
    v_mfma_f32_32x32x16_bf16 v[240:255], a[164:167], v[68:71], v[240:255]
    v_mul_f32 v181, v181, v189
    v_mul_f32 v182, v182, v190
    v_mul_f32 v183, v183, v191
    v_cvt_pk_bf16_f32 v176, v176, v177
    v_mfma_f32_32x32x16_bf16 v[240:255], a[180:183], v[76:79], v[240:255]
    v_cvt_pk_bf16_f32 v177, v178, v179
    v_cvt_pk_bf16_f32 v178, v180, v181
    v_cvt_pk_bf16_f32 v179, v182, v183
    buffer_store_dwordx4 v[176:179], v7, s[40:43], s72 offen sc1
    v_mfma_f32_32x32x16_bf16 v[240:255], a[220:223], v[8:11], v[240:255]
    s_nop 11
    v_mul_f32 v240, v240, v248
    v_mul_f32 v241, v241, v249
    v_mul_f32 v242, v242, v250
    v_mul_f32 v243, v243, v251
    v_mul_f32 v244, v244, v252
    v_mul_f32 v245, v245, v253
    v_mul_f32 v246, v246, v254
    v_mul_f32 v247, v247, v255
    v_cvt_pk_bf16_f32 v240, v240, v241
    v_cvt_pk_bf16_f32 v241, v242, v243
    v_cvt_pk_bf16_f32 v242, v244, v245
    v_cvt_pk_bf16_f32 v243, v246, v247
    buffer_store_dwordx4 v[240:243], v7, s[40:43], s73 offen sc1
    s_waitcnt lgkmcnt(0)
    s_xor_b32 s72, s48, 1
    s_mul_i32 s72, s72, 12288
    s_add_u32 s72, s72, 98304
    v_add_u32 v24, s72, v2
    s_xor_b32 s72, s48, 2
    s_mul_i32 s72, s72, 12288
    s_add_u32 s72, s72, 102400
    v_add_u32 v25, s72, v2
    s_xor_b32 s72, s48, 3
    s_mul_i32 s72, s72, 12288
    s_add_u32 s72, s72, 106496
    v_add_u32 v26, s72, v2
    s_mul_i32 s72, s48, 12288
    s_add_u32 s72, s72, 98304
    v_add_u32 v27, s72, v2
    s_lshr_b32 s72, s48, 1
    s_mul_i32 s72, s72, 114688
    v_mov_b32 v28, v2
    v_add_u32 v22, s72, v28
    s_sub_u32 s72, 114688, s72
    v_add_u32 v23, s72, v28
    s_mul_i32 s74, s56, 224
    s_mul_i32 s73, s48, 28
    s_add_u32 s74, s74, s73
    s_lshl_b32 s74, s74, 10
    s_add_u32 s80, s74, s97
    v_lshrrev_b32 v28, 5, v1
    v_lshl_add_u32 v17, v28, 4, v17
    s_add_u32 m0, s67, 102400
    s_add_u32 s76, s94, 344064
    buffer_load_dwordx4 v3, s[32:35], s76 offen lds
    buffer_load_dwordx4 v4, s[32:35], s76 offen offset:1024 lds
    s_add_u32 m0, s67, 104448
    s_add_u32 s76, s94, 360448
    buffer_load_dwordx4 v3, s[32:35], s76 offen lds
    buffer_load_dwordx4 v4, s[32:35], s76 offen offset:1024 lds
    s_add_u32 m0, s98, 139264
    s_add_u32 s76, s94, 376832
    buffer_load_dwordx4 v3, s[32:35], s76 offen lds
    buffer_load_dwordx4 v4, s[32:35], s76 offen offset:1024 lds
    s_waitcnt vmcnt(6) lgkmcnt(0)
    s_barrier
    s_cmp_lg_u32 s48, 0
    s_cbranch_scc1 PUB_34
    s_lshl_b32 s72, s49, 5
    s_add_u32 s72, s72, s50
    s_lshl_b32 s72, s72, 7
    s_add_u32 s72, s72, 25362432
    v_mov_b32 v28, s54
    v_mov_b32 v29, s55
    s_mov_b64 exec, 1
    s_cmp_lg_u32 s95, 0
    s_cbranch_scc1 FA_35
    buffer_store_dwordx2 v[28:29], off, s[40:43], s72 sc1
    s_branch FB_36
FA_35:
    buffer_store_dwordx2 v[28:29], off, s[40:43], s72
FB_36:
    s_mov_b64 exec, -1
PUB_34:
    s_lshr_b32 s72, s48, 1
    s_lshl1_add_u32 s72, s56, s72
    s_lshl_b32 s72, s72, 7
    s_add_u32 s72, s72, 131584
    v_and_b32 v28, 31, v1
    v_lshl_add_u32 v28, v28, 2, s72
    ds_read_b32 v16, v28
    s_add_u32 m0, s98, 141312
    s_add_u32 s76, s94, 393216
    buffer_load_dwordx4 v3, s[32:35], s76 offen lds
    buffer_load_dwordx4 v4, s[32:35], s76 offen offset:1024 lds
    s_add_u32 m0, s98, 143360
    s_add_u32 s76, s94, 409600
    buffer_load_dwordx4 v3, s[32:35], s76 offen lds
    buffer_load_dwordx4 v4, s[32:35], s76 offen offset:1024 lds
    s_add_u32 m0, s67, 0
    s_add_u32 s76, s94, 425984
    buffer_load_dwordx4 v3, s[32:35], s76 offen lds
    buffer_load_dwordx4 v4, s[32:35], s76 offen offset:1024 lds
    s_add_u32 m0, s67, 2048
    s_add_u32 s76, s94, 442368
    buffer_load_dwordx4 v3, s[32:35], s76 offen lds
    buffer_load_dwordx4 v4, s[32:35], s76 offen offset:1024 lds
    s_add_u32 m0, s67, 4096
    s_add_u32 s76, s94, 0
    buffer_load_dwordx4 v3, s[32:35], s76 offen lds
    buffer_load_dwordx4 v4, s[32:35], s76 offen offset:1024 lds
    s_add_u32 m0, s67, 6144
    s_add_u32 s76, s94, 16384
    buffer_load_dwordx4 v3, s[32:35], s76 offen lds
    buffer_load_dwordx4 v4, s[32:35], s76 offen offset:1024 lds
    s_add_u32 m0, s67, 32768
    s_add_u32 s76, s94, 32768
    buffer_load_dwordx4 v3, s[32:35], s76 offen lds
    buffer_load_dwordx4 v4, s[32:35], s76 offen offset:1024 lds
    s_add_u32 m0, s67, 34816
    s_add_u32 s76, s94, 49152
    buffer_load_dwordx4 v3, s[32:35], s76 offen lds
    buffer_load_dwordx4 v4, s[32:35], s76 offen offset:1024 lds
    s_waitcnt lgkmcnt(0)
    s_branch L_CJOIN
L_NOC:
    s_sub_u32 s72, s50, 28
    s_lshl2_add_u32 s74, s72, s48
    s_mul_i32 s72, s74, 114688
    v_lshlrev_b32 v28, 10, v1
    v_lshlrev_b32 v29, 7, v1
    s_mul_i32 s74, s74, 40960
    s_add_u32 s74, s74, s97
    s_add_u32 s74, s74, 262144
    s_cmp_eq_u32 s95, 0
    s_cselect_b32 s74, 0x10000000, s74
    s_mov_b32 s26, 1835008
    s_mov_b32 s30, 1835008
    s_sub_u32 s72, s50, 28
    s_lshl2_add_u32 s72, s72, s48
    s_lshl_b32 s72, s72, 4
    s_add_u32 s72, s72, 256
    s_mul_i32 s72, s72, 3584
    v_lshrrev_b32 v30, 2, v1
    v_mul_u32_u24 v31, 3584, v30
    v_and_b32 v30, 1, v30
    v_lshl_add_u32 v31, v30, 9, v31
    v_and_b32 v30, 3, v1
    v_lshl_add_u32 v31, v30, 10, v31
    buffer_load_dword a255, v31, s[24:27], s72 offen offset:384
    buffer_load_dword a255, v31, s[28:31], s72 offen offset:384
    s_add_u32 m0, s67, 34816
    s_add_u32 s76, s94, 65536
    buffer_load_dwordx4 v3, s[32:35], s76 offen lds
    buffer_load_dwordx4 v4, s[32:35], s76 offen offset:1024 lds
    s_add_u32 m0, s67, 32768
    s_add_u32 s76, s94, 81920
    buffer_load_dwordx4 v3, s[32:35], s76 offen lds
    buffer_load_dwordx4 v4, s[32:35], s76 offen offset:1024 lds
    s_add_u32 m0, s67, 6144
    s_add_u32 s76, s94, 98304
    buffer_load_dwordx4 v3, s[32:35], s76 offen lds
    buffer_load_dwordx4 v4, s[32:35], s76 offen offset:1024 lds
    s_add_u32 m0, s67, 4096
    s_add_u32 s76, s94, 114688
    buffer_load_dwordx4 v3, s[32:35], s76 offen lds
    buffer_load_dwordx4 v4, s[32:35], s76 offen offset:1024 lds
    s_add_u32 m0, s67, 2048
    s_add_u32 s76, s94, 131072
    buffer_load_dwordx4 v3, s[32:35], s76 offen lds
    buffer_load_dwordx4 v4, s[32:35], s76 offen offset:1024 lds
    s_add_u32 m0, s67, 0
    s_add_u32 s76, s94, 147456
    buffer_load_dwordx4 v3, s[32:35], s76 offen lds
    buffer_load_dwordx4 v4, s[32:35], s76 offen offset:1024 lds
    s_add_u32 m0, s98, 143360
    s_add_u32 s76, s94, 163840
    buffer_load_dwordx4 v3, s[32:35], s76 offen lds
    buffer_load_dwordx4 v4, s[32:35], s76 offen offset:1024 lds
    s_waitcnt vmcnt(12)
    ds_read_b64_tr_b16 a[32:33], v18 offset:34816
    ds_read_b64_tr_b16 a[34:35], v18 offset:35840
    ds_read_b64_tr_b16 a[36:37], v19 offset:34816
    ds_read_b64_tr_b16 a[38:39], v19 offset:35840
    s_add_u32 m0, s98, 141312
    s_add_u32 s76, s94, 180224
    buffer_load_dwordx4 v3, s[32:35], s76 offen lds
    buffer_load_dwordx4 v4, s[32:35], s76 offen offset:1024 lds
    s_waitcnt vmcnt(12)
    ds_read_b64_tr_b16 a[40:41], v18 offset:32768
    ds_read_b64_tr_b16 a[42:43], v18 offset:33792
    ds_read_b64_tr_b16 a[44:45], v19 offset:32768
    ds_read_b64_tr_b16 a[46:47], v19 offset:33792
    s_add_u32 m0, s98, 139264
    s_add_u32 s76, s94, 196608
    buffer_load_dwordx4 v3, s[32:35], s76 offen lds
    buffer_load_dwordx4 v4, s[32:35], s76 offen offset:1024 lds
    s_waitcnt vmcnt(12)
    ds_read_b64_tr_b16 a[48:49], v18 offset:6144
    ds_read_b64_tr_b16 a[50:51], v18 offset:7168
    ds_read_b64_tr_b16 a[52:53], v19 offset:6144
    ds_read_b64_tr_b16 a[54:55], v19 offset:7168
    s_add_u32 m0, s67, 36864
    s_add_u32 s76, s94, 212992
    buffer_load_dwordx4 v3, s[32:35], s76 offen lds
    buffer_load_dwordx4 v4, s[32:35], s76 offen offset:1024 lds
    s_waitcnt vmcnt(12)
    ds_read_b64_tr_b16 a[56:57], v18 offset:4096
    ds_read_b64_tr_b16 a[58:59], v18 offset:5120
    ds_read_b64_tr_b16 a[60:61], v19 offset:4096
    ds_read_b64_tr_b16 a[62:63], v19 offset:5120
    s_add_u32 m0, s67, 38912
    s_add_u32 s76, s94, 229376
    buffer_load_dwordx4 v3, s[32:35], s76 offen lds
    buffer_load_dwordx4 v4, s[32:35], s76 offen offset:1024 lds
    s_waitcnt vmcnt(12)
    ds_read_b64_tr_b16 a[64:65], v18 offset:2048
    ds_read_b64_tr_b16 a[66:67], v18 offset:3072
    ds_read_b64_tr_b16 a[68:69], v19 offset:2048
    ds_read_b64_tr_b16 a[70:71], v19 offset:3072
    s_add_u32 m0, s67, 65536
    s_add_u32 s76, s94, 245760
    buffer_load_dwordx4 v3, s[32:35], s76 offen lds
    buffer_load_dwordx4 v4, s[32:35], s76 offen offset:1024 lds
    s_waitcnt vmcnt(12)
    ds_read_b64_tr_b16 a[72:73], v18 offset:0
    ds_read_b64_tr_b16 a[74:75], v18 offset:1024
    ds_read_b64_tr_b16 a[76:77], v19 offset:0
    ds_read_b64_tr_b16 a[78:79], v19 offset:1024
    s_add_u32 m0, s67, 67584
    s_add_u32 s76, s94, 262144
    buffer_load_dwordx4 v3, s[32:35], s76 offen lds
    buffer_load_dwordx4 v4, s[32:35], s76 offen offset:1024 lds
    s_waitcnt vmcnt(12)
    ds_read_b64_tr_b16 a[80:81], v5 offset:4096
    ds_read_b64_tr_b16 a[82:83], v5 offset:5120
    ds_read_b64_tr_b16 a[84:85], v6 offset:4096
    ds_read_b64_tr_b16 a[86:87], v6 offset:5120
    s_add_u32 m0, s67, 69632
    s_add_u32 s76, s94, 278528
    buffer_load_dwordx4 v3, s[32:35], s76 offen lds
    buffer_load_dwordx4 v4, s[32:35], s76 offen offset:1024 lds
    s_waitcnt vmcnt(12)
    ds_read_b64_tr_b16 a[88:89], v5 offset:2048
    ds_read_b64_tr_b16 a[90:91], v5 offset:3072
    ds_read_b64_tr_b16 a[92:93], v6 offset:2048
    ds_read_b64_tr_b16 a[94:95], v6 offset:3072
    s_add_u32 m0, s67, 71680
    s_add_u32 s76, s94, 294912
    buffer_load_dwordx4 v3, s[32:35], s76 offen lds
    buffer_load_dwordx4 v4, s[32:35], s76 offen offset:1024 lds
    s_waitcnt vmcnt(12)
    ds_read_b64_tr_b16 a[96:97], v5 offset:0
    ds_read_b64_tr_b16 a[98:99], v5 offset:1024
    ds_read_b64_tr_b16 a[100:101], v6 offset:0
    ds_read_b64_tr_b16 a[102:103], v6 offset:1024
    s_add_u32 m0, s67, 98304
    s_add_u32 s76, s94, 311296
    buffer_load_dwordx4 v3, s[32:35], s76 offen lds
    buffer_load_dwordx4 v4, s[32:35], s76 offen offset:1024 lds
    s_add_u32 m0, s67, 100352
    s_add_u32 s76, s94, 327680
    buffer_load_dwordx4 v3, s[32:35], s76 offen lds
    buffer_load_dwordx4 v4, s[32:35], s76 offen offset:1024 lds
    s_add_u32 m0, s67, 102400
    s_add_u32 s76, s94, 344064
    buffer_load_dwordx4 v3, s[32:35], s76 offen lds
    buffer_load_dwordx4 v4, s[32:35], s76 offen offset:1024 lds
    s_add_u32 m0, s67, 104448
    s_add_u32 s76, s94, 360448
    buffer_load_dwordx4 v3, s[32:35], s76 offen lds
    buffer_load_dwordx4 v4, s[32:35], s76 offen offset:1024 lds
    s_waitcnt lgkmcnt(0)
    s_add_u32 m0, s98, 139264
    s_add_u32 s76, s94, 376832
    buffer_load_dwordx4 v3, s[32:35], s76 offen lds
    buffer_load_dwordx4 v4, s[32:35], s76 offen offset:1024 lds
    s_add_u32 m0, s98, 141312
    s_add_u32 s76, s94, 393216
    buffer_load_dwordx4 v3, s[32:35], s76 offen lds
    buffer_load_dwordx4 v4, s[32:35], s76 offen offset:1024 lds
    s_add_u32 m0, s98, 143360
    s_add_u32 s76, s94, 409600
    buffer_load_dwordx4 v3, s[32:35], s76 offen lds
    buffer_load_dwordx4 v4, s[32:35], s76 offen offset:1024 lds
    s_add_u32 m0, s67, 0
    s_add_u32 s76, s94, 425984
    buffer_load_dwordx4 v3, s[32:35], s76 offen lds
    buffer_load_dwordx4 v4, s[32:35], s76 offen offset:1024 lds
    s_add_u32 m0, s67, 2048
    s_add_u32 s76, s94, 442368
    buffer_load_dwordx4 v3, s[32:35], s76 offen lds
    buffer_load_dwordx4 v4, s[32:35], s76 offen offset:1024 lds
    s_add_u32 m0, s67, 4096
    s_add_u32 s76, s94, 0
    buffer_load_dwordx4 v3, s[32:35], s76 offen lds
    buffer_load_dwordx4 v4, s[32:35], s76 offen offset:1024 lds
    s_add_u32 m0, s67, 6144
    s_add_u32 s76, s94, 16384
    buffer_load_dwordx4 v3, s[32:35], s76 offen lds
    buffer_load_dwordx4 v4, s[32:35], s76 offen offset:1024 lds
    s_add_u32 m0, s67, 32768
    s_add_u32 s76, s94, 32768
    buffer_load_dwordx4 v3, s[32:35], s76 offen lds
    buffer_load_dwordx4 v4, s[32:35], s76 offen offset:1024 lds
    s_add_u32 m0, s67, 34816
    s_add_u32 s76, s94, 49152
    buffer_load_dwordx4 v3, s[32:35], s76 offen lds
    buffer_load_dwordx4 v4, s[32:35], s76 offen offset:1024 lds
    s_xor_b32 s72, s48, 1
    s_mul_i32 s72, s72, 12288
    s_add_u32 s72, s72, 98304
    v_add_u32 v24, s72, v2
    s_xor_b32 s72, s48, 2
    s_mul_i32 s72, s72, 12288
    s_add_u32 s72, s72, 102400
    v_add_u32 v25, s72, v2
    s_xor_b32 s72, s48, 3
    s_mul_i32 s72, s72, 12288
    s_add_u32 s72, s72, 106496
    v_add_u32 v26, s72, v2
    s_mul_i32 s72, s48, 12288
    s_add_u32 s72, s72, 98304
    v_add_u32 v27, s72, v2
    s_lshr_b32 s72, s48, 1
    s_mul_i32 s72, s72, 114688
    v_mov_b32 v28, v2
    v_add_u32 v22, s72, v28
    s_sub_u32 s72, 114688, s72
    v_add_u32 v23, s72, v28
    s_mul_i32 s74, s56, 224
    s_mul_i32 s73, s48, 28
    s_add_u32 s74, s74, s73
    s_lshl_b32 s74, s74, 10
    s_add_u32 s80, s74, s97
    v_lshrrev_b32 v28, 5, v1
    v_lshl_add_u32 v17, v28, 4, v17
    s_cmp_lg_u32 s48, 0
    s_cbranch_scc1 POLLX_37
    s_lshl_b32 s72, s49, 12
    s_add_u32 s72, s72, 25296896
    v_min_u32 v30, 31, v1
    v_lshlrev_b32 v30, 7, v30
    s_mov_b32 s73, 0
POLL_38:
    buffer_load_dwordx2 v[28:29], v30, s[40:43], s72 offen sc1
    s_add_u32 s73, s73, 1
    s_waitcnt vmcnt(0)
    v_cmp_ne_u64 vcc, s[54:55], v[28:29]
    s_cmp_gt_u32 s73, 0x400000
    s_cbranch_scc1 POLLX_37
    s_cmp_lg_u64 vcc, 0
    s_cbranch_scc1 POLL_38
POLLX_37:
    s_barrier
    s_lshl2_add_u32 s72, s49, s56
    s_lshl_b32 s72, s72, 13
    s_add_u32 s72, s72, 5242880
    s_add_u32 s73, s72, 4096
    buffer_load_dwordx4 v[128:131], v2, s[40:43], s72 offen offset:0 sc1
    buffer_load_dwordx4 v[132:135], v2, s[40:43], s72 offen offset:1024 sc1
    buffer_load_dwordx4 v[136:139], v2, s[40:43], s72 offen offset:2048 sc1
    buffer_load_dwordx4 v[140:143], v2, s[40:43], s72 offen offset:3072 sc1
    buffer_load_dwordx4 v[144:147], v2, s[40:43], s73 offen offset:0 sc1
    buffer_load_dwordx4 v[148:151], v2, s[40:43], s73 offen offset:1024 sc1
    buffer_load_dwordx4 v[152:155], v2, s[40:43], s73 offen offset:2048 sc1
    buffer_load_dwordx4 v[156:159], v2, s[40:43], s73 offen offset:3072 sc1
    s_waitcnt vmcnt(0)
    v_pk_add_f32 v[128:129], v[128:129], v[132:133]
    v_pk_add_f32 v[130:131], v[130:131], v[134:135]
    v_pk_add_f32 v[128:129], v[128:129], v[136:137]
    v_pk_add_f32 v[130:131], v[130:131], v[138:139]
    v_pk_add_f32 v[128:129], v[128:129], v[140:141]
    v_pk_add_f32 v[130:131], v[130:131], v[142:143]
    v_pk_add_f32 v[128:129], v[128:129], v[144:145]
    v_pk_add_f32 v[130:131], v[130:131], v[146:147]
    v_pk_add_f32 v[128:129], v[128:129], v[148:149]
    v_pk_add_f32 v[130:131], v[130:131], v[150:151]
    v_pk_add_f32 v[128:129], v[128:129], v[152:153]
    v_pk_add_f32 v[130:131], v[130:131], v[154:155]
    v_pk_add_f32 v[128:129], v[128:129], v[156:157]
    v_pk_add_f32 v[130:131], v[130:131], v[158:159]
    s_cmp_gt_u32 s48, 1
    s_cselect_b64 vcc, -1, 0
    v_cndmask_b32 v128, v128, v130, vcc
    v_cndmask_b32 v129, v129, v131, vcc
    s_nop 1
    v_permlane32_swap_b32 v128, v129
    v_add_f32 v128, v128, v129
    v_mov_b32 v129, v128
    s_nop 1
    v_permlane32_swap_b32 v128, v129
    v_mul_f32 v28, 0x3b000000, v128
    v_mul_f32 v129, 0x3b000000, v129
    v_fma_f32 v129, -v28, v28, v129
    v_max_f32 v129, 0, v129
    v_add_f32 v129, 0x3727c5ac, v129
    v_rsq_f32 v29, v129
    s_nop 0
    v_mul_f32 v16, v29, v29
    s_waitcnt vmcnt(0) lgkmcnt(0)
L_CJOIN:
    s_cmp_lg_u32 s48, 0
    s_cbranch_scc1 POLLX_40
    s_lshl_b32 s72, s49, 12
    s_add_u32 s72, s72, 25362432
    v_min_u32 v30, 27, v1
    v_lshlrev_b32 v30, 7, v30
    s_mov_b32 s73, 0
POLL_41:
    buffer_load_dwordx2 v[28:29], v30, s[40:43], s72 offen sc1
    s_add_u32 s73, s73, 1
    s_waitcnt vmcnt(0)
    v_cmp_ne_u64 vcc, s[54:55], v[28:29]
    s_cmp_gt_u32 s73, 0x400000
    s_cbranch_scc1 POLLX_40
    s_cmp_lg_u64 vcc, 0
    s_cbranch_scc1 POLL_41
POLLX_40:
    s_barrier
    s_add_u32 s81, s80, 4096
    buffer_load_dwordx4 v[128:131], v22, s[40:43], s81 offen offset:0 sc1
    buffer_load_dwordx4 v[132:135], v23, s[40:43], s81 offen offset:0 sc1
    buffer_load_dwordx4 v[136:139], v22, s[40:43], s81 offen offset:1024 sc1
    buffer_load_dwordx4 v[140:143], v23, s[40:43], s81 offen offset:1024 sc1
    buffer_load_dwordx4 v[144:147], v22, s[40:43], s81 offen offset:2048 sc1
    buffer_load_dwordx4 v[148:151], v23, s[40:43], s81 offen offset:2048 sc1
    buffer_load_dwordx4 v[152:155], v22, s[40:43], s81 offen offset:3072 sc1
    buffer_load_dwordx4 v[156:159], v23, s[40:43], s81 offen offset:3072 sc1
    s_add_u32 s81, s80, 8192
    buffer_load_dwordx4 v[160:163], v22, s[40:43], s81 offen offset:0 sc1
    buffer_load_dwordx4 v[164:167], v23, s[40:43], s81 offen offset:0 sc1
    buffer_load_dwordx4 v[168:171], v22, s[40:43], s81 offen offset:1024 sc1
    buffer_load_dwordx4 v[172:175], v23, s[40:43], s81 offen offset:1024 sc1
    buffer_load_dwordx4 v[176:179], v22, s[40:43], s81 offen offset:2048 sc1
    buffer_load_dwordx4 v[180:183], v23, s[40:43], s81 offen offset:2048 sc1
    s_waitcnt vmcnt(12)
    v_mfma_f32_32x32x16_bf16 v[48:63], a[36:39], v[128:131], 0
    ds_read_b64_tr_b16 a[104:105], v18 offset:36864
    buffer_load_dwordx4 v[184:187], v22, s[40:43], s81 offen offset:3072 sc1
    v_mfma_f32_32x32x16_bf16 v[64:79], a[32:35], v[132:135], 0
    ds_read_b64_tr_b16 a[106:107], v18 offset:37888
    v_mfma_f32_32x32x16_bf16 v[80:95], a[36:39], v[132:135], 0
    ds_read_b64_tr_b16 a[108:109], v19 offset:36864
    buffer_load_dwordx4 v[188:191], v23, s[40:43], s81 offen offset:3072 sc1
    v_mfma_f32_32x32x16_bf16 v[32:47], a[32:35], v[128:131], 0
    ds_read_b64_tr_b16 a[110:111], v19 offset:37888
    s_waitcnt vmcnt(12)
    v_mfma_f32_32x32x16_bf16 v[48:63], a[44:47], v[136:139], v[48:63]
    ds_read_b64_tr_b16 a[112:113], v18 offset:38912
    s_add_u32 s81, s80, 12288
    buffer_load_dwordx4 v[192:195], v22, s[40:43], s81 offen offset:0 sc1
    v_mfma_f32_32x32x16_bf16 v[64:79], a[40:43], v[140:143], v[64:79]
    ds_read_b64_tr_b16 a[114:115], v18 offset:39936
    v_mfma_f32_32x32x16_bf16 v[80:95], a[44:47], v[140:143], v[80:95]
    ds_read_b64_tr_b16 a[116:117], v19 offset:38912
    buffer_load_dwordx4 v[196:199], v23, s[40:43], s81 offen offset:0 sc1
    v_mfma_f32_32x32x16_bf16 v[32:47], a[40:43], v[136:139], v[32:47]
    ds_read_b64_tr_b16 a[118:119], v19 offset:39936
    s_waitcnt vmcnt(12)
    v_mfma_f32_32x32x16_bf16 v[48:63], a[52:55], v[144:147], v[48:63]
    ds_read_b64_tr_b16 a[120:121], v20 offset:0
    buffer_load_dwordx4 v[200:203], v22, s[40:43], s81 offen offset:1024 sc1
    v_mfma_f32_32x32x16_bf16 v[64:79], a[48:51], v[148:151], v[64:79]
    ds_read_b64_tr_b16 a[122:123], v20 offset:1024
    v_mfma_f32_32x32x16_bf16 v[80:95], a[52:55], v[148:151], v[80:95]
    ds_read_b64_tr_b16 a[124:125], v21 offset:0
    buffer_load_dwordx4 v[204:207], v23, s[40:43], s81 offen offset:1024 sc1
    v_mfma_f32_32x32x16_bf16 v[32:47], a[48:51], v[144:147], v[32:47]
    ds_read_b64_tr_b16 a[126:127], v21 offset:1024
    s_waitcnt vmcnt(12)
    v_mfma_f32_32x32x16_bf16 v[48:63], a[60:63], v[152:155], v[48:63]
    ds_read_b64_tr_b16 a[128:129], v20 offset:2048
    buffer_load_dwordx4 v[208:211], v22, s[40:43], s81 offen offset:2048 sc1
    v_mfma_f32_32x32x16_bf16 v[64:79], a[56:59], v[156:159], v[64:79]
    ds_read_b64_tr_b16 a[130:131], v20 offset:3072
    v_mfma_f32_32x32x16_bf16 v[80:95], a[60:63], v[156:159], v[80:95]
    ds_read_b64_tr_b16 a[132:133], v21 offset:2048
    buffer_load_dwordx4 v[212:215], v23, s[40:43], s81 offen offset:2048 sc1
    v_mfma_f32_32x32x16_bf16 v[32:47], a[56:59], v[152:155], v[32:47]
    ds_read_b64_tr_b16 a[134:135], v21 offset:3072
    s_waitcnt vmcnt(12)
    v_mfma_f32_32x32x16_bf16 v[48:63], a[68:71], v[160:163], v[48:63]
    ds_read_b64_tr_b16 a[136:137], v20 offset:4096
    buffer_load_dwordx4 v[216:219], v22, s[40:43], s81 offen offset:3072 sc1
    v_mfma_f32_32x32x16_bf16 v[64:79], a[64:67], v[164:167], v[64:79]
    ds_read_b64_tr_b16 a[138:139], v20 offset:5120
    v_mfma_f32_32x32x16_bf16 v[80:95], a[68:71], v[164:167], v[80:95]
    ds_read_b64_tr_b16 a[140:141], v21 offset:4096
    buffer_load_dwordx4 v[220:223], v23, s[40:43], s81 offen offset:3072 sc1
    v_mfma_f32_32x32x16_bf16 v[32:47], a[64:67], v[160:163], v[32:47]
    ds_read_b64_tr_b16 a[142:143], v21 offset:5120
    s_waitcnt vmcnt(12)
    v_mfma_f32_32x32x16_bf16 v[48:63], a[76:79], v[168:171], v[48:63]
    ds_read_b64_tr_b16 a[144:145], v20 offset:6144
    s_add_u32 s81, s80, 16384
    buffer_load_dwordx4 v[224:227], v22, s[40:43], s81 offen offset:0 sc1
    v_mfma_f32_32x32x16_bf16 v[64:79], a[72:75], v[172:175], v[64:79]
    ds_read_b64_tr_b16 a[146:147], v20 offset:7168
    v_mfma_f32_32x32x16_bf16 v[80:95], a[76:79], v[172:175], v[80:95]
    ds_read_b64_tr_b16 a[148:149], v21 offset:6144
    buffer_load_dwordx4 v[228:231], v23, s[40:43], s81 offen offset:0 sc1
    v_mfma_f32_32x32x16_bf16 v[32:47], a[72:75], v[168:171], v[32:47]
    ds_read_b64_tr_b16 a[150:151], v21 offset:7168
    s_waitcnt vmcnt(12)
    v_mfma_f32_32x32x16_bf16 v[48:63], a[84:87], v[176:179], v[48:63]
    ds_read_b64_tr_b16 a[152:153], v20 offset:32768
    buffer_load_dwordx4 v[232:235], v22, s[40:43], s81 offen offset:1024 sc1
    v_mfma_f32_32x32x16_bf16 v[64:79], a[80:83], v[180:183], v[64:79]
    ds_read_b64_tr_b16 a[154:155], v20 offset:33792
    v_mfma_f32_32x32x16_bf16 v[80:95], a[84:87], v[180:183], v[80:95]
    ds_read_b64_tr_b16 a[156:157], v21 offset:32768
    buffer_load_dwordx4 v[236:239], v23, s[40:43], s81 offen offset:1024 sc1
    v_mfma_f32_32x32x16_bf16 v[32:47], a[80:83], v[176:179], v[32:47]
    ds_read_b64_tr_b16 a[158:159], v21 offset:33792
    s_waitcnt vmcnt(12)
    v_mfma_f32_32x32x16_bf16 v[48:63], a[92:95], v[184:187], v[48:63]
    ds_read_b64_tr_b16 a[160:161], v20 offset:34816
    buffer_load_dwordx4 v[240:243], v22, s[40:43], s81 offen offset:2048 sc1
    v_mfma_f32_32x32x16_bf16 v[64:79], a[88:91], v[188:191], v[64:79]
    ds_read_b64_tr_b16 a[162:163], v20 offset:35840
    v_mfma_f32_32x32x16_bf16 v[80:95], a[92:95], v[188:191], v[80:95]
    ds_read_b64_tr_b16 a[164:165], v21 offset:34816
    buffer_load_dwordx4 v[244:247], v23, s[40:43], s81 offen offset:2048 sc1
    v_mfma_f32_32x32x16_bf16 v[32:47], a[88:91], v[184:187], v[32:47]
    ds_read_b64_tr_b16 a[166:167], v21 offset:35840
    s_waitcnt vmcnt(12)
    v_mfma_f32_32x32x16_bf16 v[48:63], a[100:103], v[192:195], v[48:63]
    ds_read_b64_tr_b16 a[168:169], v20 offset:36864
    buffer_load_dwordx4 v[248:251], v22, s[40:43], s81 offen offset:3072 sc1
    v_mfma_f32_32x32x16_bf16 v[64:79], a[96:99], v[196:199], v[64:79]
    ds_read_b64_tr_b16 a[170:171], v20 offset:37888
    v_mfma_f32_32x32x16_bf16 v[80:95], a[100:103], v[196:199], v[80:95]
    ds_read_b64_tr_b16 a[172:173], v21 offset:36864
    buffer_load_dwordx4 v[252:255], v23, s[40:43], s81 offen offset:3072 sc1
    v_mfma_f32_32x32x16_bf16 v[32:47], a[96:99], v[192:195], v[32:47]
    ds_read_b64_tr_b16 a[174:175], v21 offset:37888
    s_waitcnt vmcnt(12) lgkmcnt(15)
    v_mfma_f32_32x32x16_bf16 v[48:63], a[108:111], v[200:203], v[48:63]
    ds_read_b64_tr_b16 a[176:177], v20 offset:38912
    s_add_u32 s81, s80, 20480
    buffer_load_dwordx4 v[128:131], v22, s[40:43], s81 offen offset:0 sc1
    v_mfma_f32_32x32x16_bf16 v[64:79], a[104:107], v[204:207], v[64:79]
    ds_read_b64_tr_b16 a[178:179], v20 offset:39936
    v_mfma_f32_32x32x16_bf16 v[80:95], a[108:111], v[204:207], v[80:95]
    ds_read_b64_tr_b16 a[180:181], v21 offset:38912
    buffer_load_dwordx4 v[132:135], v23, s[40:43], s81 offen offset:0 sc1
    v_mfma_f32_32x32x16_bf16 v[32:47], a[104:107], v[200:203], v[32:47]
    ds_read_b64_tr_b16 a[182:183], v21 offset:39936
    s_waitcnt vmcnt(12)
    v_mfma_f32_32x32x16_bf16 v[48:63], a[116:119], v[208:211], v[48:63]
    ds_read_b64_tr_b16 a[184:185], v5 offset:0
    buffer_load_dwordx4 v[136:139], v22, s[40:43], s81 offen offset:1024 sc1
    v_mfma_f32_32x32x16_bf16 v[64:79], a[112:115], v[212:215], v[64:79]
    ds_read_b64_tr_b16 a[186:187], v5 offset:1024
    v_mfma_f32_32x32x16_bf16 v[80:95], a[116:119], v[212:215], v[80:95]
    ds_read_b64_tr_b16 a[188:189], v6 offset:0
    buffer_load_dwordx4 v[140:143], v23, s[40:43], s81 offen offset:1024 sc1
    v_mfma_f32_32x32x16_bf16 v[32:47], a[112:115], v[208:211], v[32:47]
    ds_read_b64_tr_b16 a[190:191], v6 offset:1024
    s_waitcnt vmcnt(12)
    v_mfma_f32_32x32x16_bf16 v[48:63], a[124:127], v[216:219], v[48:63]
    ds_read_b64_tr_b16 a[192:193], v5 offset:2048
    buffer_load_dwordx4 v[144:147], v22, s[40:43], s81 offen offset:2048 sc1
    v_mfma_f32_32x32x16_bf16 v[64:79], a[120:123], v[220:223], v[64:79]
    ds_read_b64_tr_b16 a[194:195], v5 offset:3072
    v_mfma_f32_32x32x16_bf16 v[80:95], a[124:127], v[220:223], v[80:95]
    ds_read_b64_tr_b16 a[196:197], v6 offset:2048
    buffer_load_dwordx4 v[148:151], v23, s[40:43], s81 offen offset:2048 sc1
    v_mfma_f32_32x32x16_bf16 v[32:47], a[120:123], v[216:219], v[32:47]
    ds_read_b64_tr_b16 a[198:199], v6 offset:3072
    s_waitcnt vmcnt(12)
    v_mfma_f32_32x32x16_bf16 v[48:63], a[132:135], v[224:227], v[48:63]
    ds_read_b64_tr_b16 a[200:201], v5 offset:4096
    buffer_load_dwordx4 v[152:155], v22, s[40:43], s81 offen offset:3072 sc1
    v_mfma_f32_32x32x16_bf16 v[64:79], a[128:131], v[228:231], v[64:79]
    ds_read_b64_tr_b16 a[202:203], v5 offset:5120
    v_mfma_f32_32x32x16_bf16 v[80:95], a[132:135], v[228:231], v[80:95]
    ds_read_b64_tr_b16 a[204:205], v6 offset:4096
    buffer_load_dwordx4 v[156:159], v23, s[40:43], s81 offen offset:3072 sc1
    v_mfma_f32_32x32x16_bf16 v[32:47], a[128:131], v[224:227], v[32:47]
    ds_read_b64_tr_b16 a[206:207], v6 offset:5120
    s_waitcnt vmcnt(12)
    v_mfma_f32_32x32x16_bf16 v[48:63], a[140:143], v[232:235], v[48:63]
    ds_read_b64_tr_b16 a[208:209], v18 offset:0
    s_add_u32 s81, s80, 24576
    buffer_load_dwordx4 v[160:163], v22, s[40:43], s81 offen offset:0 sc1
    v_mfma_f32_32x32x16_bf16 v[64:79], a[136:139], v[236:239], v[64:79]
    ds_read_b64_tr_b16 a[210:211], v18 offset:1024
    v_mfma_f32_32x32x16_bf16 v[80:95], a[140:143], v[236:239], v[80:95]
    ds_read_b64_tr_b16 a[212:213], v19 offset:0
    buffer_load_dwordx4 v[164:167], v23, s[40:43], s81 offen offset:0 sc1
    v_mfma_f32_32x32x16_bf16 v[32:47], a[136:139], v[232:235], v[32:47]
    ds_read_b64_tr_b16 a[214:215], v19 offset:1024
    s_waitcnt vmcnt(12) lgkmcnt(15)
    v_mfma_f32_32x32x16_bf16 v[48:63], a[148:151], v[240:243], v[48:63]
    ds_read_b64_tr_b16 a[216:217], v18 offset:2048
    buffer_load_dwordx4 v[168:171], v22, s[40:43], s81 offen offset:1024 sc1
    v_mfma_f32_32x32x16_bf16 v[64:79], a[144:147], v[244:247], v[64:79]
    ds_read_b64_tr_b16 a[218:219], v18 offset:3072
    v_mfma_f32_32x32x16_bf16 v[80:95], a[148:151], v[244:247], v[80:95]
    ds_read_b64_tr_b16 a[220:221], v19 offset:2048
    buffer_load_dwordx4 v[172:175], v23, s[40:43], s81 offen offset:1024 sc1
    v_mfma_f32_32x32x16_bf16 v[32:47], a[144:147], v[240:243], v[32:47]
    ds_read_b64_tr_b16 a[222:223], v19 offset:3072
    s_waitcnt vmcnt(12)
    v_mfma_f32_32x32x16_bf16 v[48:63], a[156:159], v[248:251], v[48:63]
    ds_read_b64_tr_b16 a[0:1], v18 offset:4096
    buffer_load_dwordx4 v[176:179], v22, s[40:43], s81 offen offset:2048 sc1
    v_mfma_f32_32x32x16_bf16 v[64:79], a[152:155], v[252:255], v[64:79]
    ds_read_b64_tr_b16 a[2:3], v18 offset:5120
    v_mfma_f32_32x32x16_bf16 v[80:95], a[156:159], v[252:255], v[80:95]
    ds_read_b64_tr_b16 a[4:5], v19 offset:4096
    buffer_load_dwordx4 v[180:183], v23, s[40:43], s81 offen offset:2048 sc1
    v_mfma_f32_32x32x16_bf16 v[32:47], a[152:155], v[248:251], v[32:47]
    ds_read_b64_tr_b16 a[6:7], v19 offset:5120
    s_waitcnt vmcnt(12)
    v_mfma_f32_32x32x16_bf16 v[48:63], a[164:167], v[128:131], v[48:63]
    ds_read_b64_tr_b16 a[8:9], v18 offset:6144
    buffer_load_dwordx4 v[184:187], v22, s[40:43], s81 offen offset:3072 sc1
    v_mfma_f32_32x32x16_bf16 v[64:79], a[160:163], v[132:135], v[64:79]
    ds_read_b64_tr_b16 a[10:11], v18 offset:7168
    v_mfma_f32_32x32x16_bf16 v[80:95], a[164:167], v[132:135], v[80:95]
    ds_read_b64_tr_b16 a[12:13], v19 offset:6144
    buffer_load_dwordx4 v[188:191], v23, s[40:43], s81 offen offset:3072 sc1
    v_mfma_f32_32x32x16_bf16 v[32:47], a[160:163], v[128:131], v[32:47]
    ds_read_b64_tr_b16 a[14:15], v19 offset:7168
    s_waitcnt vmcnt(12)
    v_mfma_f32_32x32x16_bf16 v[48:63], a[172:175], v[136:139], v[48:63]
    ds_read_b64_tr_b16 a[16:17], v18 offset:32768
    s_add_u32 s81, s80, 0
    buffer_load_dwordx4 v[192:195], v22, s[40:43], s81 offen offset:0 sc1
    v_mfma_f32_32x32x16_bf16 v[64:79], a[168:171], v[140:143], v[64:79]
    ds_read_b64_tr_b16 a[18:19], v18 offset:33792
    v_mfma_f32_32x32x16_bf16 v[80:95], a[172:175], v[140:143], v[80:95]
    ds_read_b64_tr_b16 a[20:21], v19 offset:32768
    buffer_load_dwordx4 v[196:199], v23, s[40:43], s81 offen offset:0 sc1
    v_mfma_f32_32x32x16_bf16 v[32:47], a[168:171], v[136:139], v[32:47]
    ds_read_b64_tr_b16 a[22:23], v19 offset:33792
    s_waitcnt vmcnt(12)
    v_mfma_f32_32x32x16_bf16 v[48:63], a[180:183], v[144:147], v[48:63]
    ds_read_b64_tr_b16 a[24:25], v18 offset:34816
    buffer_load_dwordx4 v[200:203], v22, s[40:43], s81 offen offset:1024 sc1
    v_mfma_f32_32x32x16_bf16 v[64:79], a[176:179], v[148:151], v[64:79]
    ds_read_b64_tr_b16 a[26:27], v18 offset:35840
    v_mfma_f32_32x32x16_bf16 v[80:95], a[180:183], v[148:151], v[80:95]
    ds_read_b64_tr_b16 a[28:29], v19 offset:34816
    buffer_load_dwordx4 v[204:207], v23, s[40:43], s81 offen offset:1024 sc1
    v_mfma_f32_32x32x16_bf16 v[32:47], a[176:179], v[144:147], v[32:47]
    ds_read_b64_tr_b16 a[30:31], v19 offset:35840
    s_waitcnt vmcnt(12) lgkmcnt(15)
    v_mfma_f32_32x32x16_bf16 v[48:63], a[188:191], v[152:155], v[48:63]
    buffer_load_dwordx4 v[208:211], v22, s[40:43], s81 offen offset:2048 sc1
    v_mfma_f32_32x32x16_bf16 v[64:79], a[184:187], v[156:159], v[64:79]
    v_mfma_f32_32x32x16_bf16 v[80:95], a[188:191], v[156:159], v[80:95]
    buffer_load_dwordx4 v[212:215], v23, s[40:43], s81 offen offset:2048 sc1
    v_mfma_f32_32x32x16_bf16 v[32:47], a[184:187], v[152:155], v[32:47]
    s_waitcnt vmcnt(12)
    v_mfma_f32_32x32x16_bf16 v[48:63], a[196:199], v[160:163], v[48:63]
    buffer_load_dwordx4 v[216:219], v22, s[40:43], s81 offen offset:3072 sc1
    v_mfma_f32_32x32x16_bf16 v[64:79], a[192:195], v[164:167], v[64:79]
    v_mfma_f32_32x32x16_bf16 v[80:95], a[196:199], v[164:167], v[80:95]
    buffer_load_dwordx4 v[220:223], v23, s[40:43], s81 offen offset:3072 sc1
    v_mfma_f32_32x32x16_bf16 v[32:47], a[192:195], v[160:163], v[32:47]
    s_waitcnt vmcnt(12)
    v_mfma_f32_32x32x16_bf16 v[48:63], a[204:207], v[168:171], v[48:63]
    v_mfma_f32_32x32x16_bf16 v[64:79], a[200:203], v[172:175], v[64:79]
    v_mfma_f32_32x32x16_bf16 v[80:95], a[204:207], v[172:175], v[80:95]
    v_mfma_f32_32x32x16_bf16 v[32:47], a[200:203], v[168:171], v[32:47]
    s_waitcnt vmcnt(10)
    v_mfma_f32_32x32x16_bf16 v[48:63], a[212:215], v[176:179], v[48:63]
    v_mfma_f32_32x32x16_bf16 v[64:79], a[208:211], v[180:183], v[64:79]
    v_mfma_f32_32x32x16_bf16 v[80:95], a[212:215], v[180:183], v[80:95]
    v_mfma_f32_32x32x16_bf16 v[32:47], a[208:211], v[176:179], v[32:47]
    s_waitcnt vmcnt(8)
    v_mfma_f32_32x32x16_bf16 v[48:63], a[220:223], v[184:187], v[48:63]
    v_mfma_f32_32x32x16_bf16 v[64:79], a[216:219], v[188:191], v[64:79]
    v_mfma_f32_32x32x16_bf16 v[80:95], a[220:223], v[188:191], v[80:95]
    v_mfma_f32_32x32x16_bf16 v[32:47], a[216:219], v[184:187], v[32:47]
    s_waitcnt vmcnt(6) lgkmcnt(12)
    v_mfma_f32_32x32x16_bf16 v[48:63], a[4:7], v[192:195], v[48:63]
    v_mfma_f32_32x32x16_bf16 v[64:79], a[0:3], v[196:199], v[64:79]
    v_mfma_f32_32x32x16_bf16 v[80:95], a[4:7], v[196:199], v[80:95]
    v_mfma_f32_32x32x16_bf16 v[32:47], a[0:3], v[192:195], v[32:47]
    s_waitcnt vmcnt(4) lgkmcnt(8)
    v_mfma_f32_32x32x16_bf16 v[48:63], a[12:15], v[200:203], v[48:63]
    s_waitcnt lgkmcnt(0)
    s_barrier
    v_mfma_f32_32x32x16_bf16 v[64:79], a[8:11], v[204:207], v[64:79]
    v_mfma_f32_32x32x16_bf16 v[80:95], a[12:15], v[204:207], v[80:95]
    v_mfma_f32_32x32x16_bf16 v[32:47], a[8:11], v[200:203], v[32:47]
    s_waitcnt vmcnt(0) lgkmcnt(0)
    v_mfma_f32_32x32x16_bf16 v[48:63], a[20:23], v[208:211], v[48:63]
    v_mfma_f32_32x32x16_bf16 v[48:63], a[28:31], v[216:219], v[48:63]
    v_mfma_f32_32x32x16_bf16 v[64:79], a[16:19], v[212:215], v[64:79]
    v_mfma_f32_32x32x16_bf16 v[64:79], a[24:27], v[220:223], v[64:79]
    v_mfma_f32_32x32x16_bf16 v[80:95], a[20:23], v[212:215], v[80:95]
    v_mfma_f32_32x32x16_bf16 v[80:95], a[28:31], v[220:223], v[80:95]
    s_nop 7
    ds_write_b128 v24, v[48:51] offset:0
    ds_write_b128 v24, v[52:55] offset:1024
    v_mfma_f32_32x32x16_bf16 v[32:47], a[16:19], v[208:211], v[32:47]
    ds_write_b128 v24, v[56:59] offset:2048
    ds_write_b128 v24, v[60:63] offset:3072
    ds_write_b128 v25, v[64:67] offset:0
    v_mfma_f32_32x32x16_bf16 v[32:47], a[24:27], v[216:219], v[32:47]
    ds_write_b128 v25, v[68:71] offset:1024
    ds_write_b128 v25, v[72:75] offset:2048
    ds_write_b128 v25, v[76:79] offset:3072
    ds_write_b128 v26, v[80:83] offset:0
    ds_write_b128 v26, v[84:87] offset:1024
    ds_write_b128 v26, v[88:91] offset:2048
    ds_write_b128 v26, v[92:95] offset:3072
    s_nop 4
    v_pk_fma_f32 v[96:97], v[32:33], v[16:17], v[96:97] op_sel_hi:[1,0,1]
    v_pk_fma_f32 v[98:99], v[34:35], v[16:17], v[98:99] op_sel_hi:[1,0,1]
    v_pk_fma_f32 v[100:101], v[36:37], v[16:17], v[100:101] op_sel_hi:[1,0,1]
    v_pk_fma_f32 v[102:103], v[38:39], v[16:17], v[102:103] op_sel_hi:[1,0,1]
    v_pk_fma_f32 v[104:105], v[40:41], v[16:17], v[104:105] op_sel_hi:[1,0,1]
    v_pk_fma_f32 v[106:107], v[42:43], v[16:17], v[106:107] op_sel_hi:[1,0,1]
    v_pk_fma_f32 v[108:109], v[44:45], v[16:17], v[108:109] op_sel_hi:[1,0,1]
    v_pk_fma_f32 v[110:111], v[46:47], v[16:17], v[110:111] op_sel_hi:[1,0,1]
    s_mul_i32 s73, s48, 4096
    v_and_b32 v28, 31, v1
    v_mul_u32_u24 v28, 80, v28
    v_lshrrev_b32 v29, 5, v1
    v_lshl_add_u32 v28, v29, 4, v28
    v_add_u32 v28, s73, v28
    v_lshrrev_b32 v30, 2, v1
    v_and_b32 v31, 3, v1
    v_mul_u32_u24 v29, 80, v30
    v_lshl_add_u32 v29, v31, 4, v29
    v_add_u32 v29, s73, v29
    v_lshlrev_b32 v30, 10, v30
    v_lshl_add_u32 v30, v31, 4, v30
    s_add_u32 s72, s86, 16384
    s_waitcnt lgkmcnt(0)
    s_barrier
    ds_read_b128 v[128:131], v27 offset:0
    ds_read_b128 v[144:147], v27 offset:4096
    ds_read_b128 v[160:163], v27 offset:8192
    ds_read_b128 v[132:135], v27 offset:1024
    ds_read_b128 v[148:151], v27 offset:5120
    ds_read_b128 v[164:167], v27 offset:9216
    ds_read_b128 v[136:139], v27 offset:2048
    ds_read_b128 v[152:155], v27 offset:6144
    ds_read_b128 v[168:171], v27 offset:10240
    ds_read_b128 v[140:143], v27 offset:3072
    ds_read_b128 v[156:159], v27 offset:7168
    ds_read_b128 v[172:175], v27 offset:11264
    s_waitcnt lgkmcnt(9)
    v_pk_add_f32 v[128:129], v[128:129], v[144:145]
    v_pk_add_f32 v[130:131], v[130:131], v[146:147]
    v_pk_add_f32 v[128:129], v[128:129], v[160:161]
    v_pk_add_f32 v[130:131], v[130:131], v[162:163]
    v_pk_fma_f32 v[96:97], v[128:129], v[16:17], v[96:97] op_sel_hi:[1,0,1]
    v_pk_fma_f32 v[98:99], v[130:131], v[16:17], v[98:99] op_sel_hi:[1,0,1]
    s_waitcnt lgkmcnt(6)
    v_pk_add_f32 v[132:133], v[132:133], v[148:149]
    v_pk_add_f32 v[134:135], v[134:135], v[150:151]
    v_pk_add_f32 v[132:133], v[132:133], v[164:165]
    v_pk_add_f32 v[134:135], v[134:135], v[166:167]
    v_pk_fma_f32 v[100:101], v[132:133], v[16:17], v[100:101] op_sel_hi:[1,0,1]
    v_pk_fma_f32 v[102:103], v[134:135], v[16:17], v[102:103] op_sel_hi:[1,0,1]
    v_cvt_pk_bf16_f32 v112, v96, v97
    v_cvt_pk_bf16_f32 v113, v98, v99
    v_cvt_pk_bf16_f32 v114, v100, v101
    v_cvt_pk_bf16_f32 v115, v102, v103
    s_nop 0
    v_permlane32_swap_b32 v112, v114
    v_permlane32_swap_b32 v113, v115
    ds_write_b128 v28, v[112:115] offset:0
    s_waitcnt lgkmcnt(4)
    v_pk_add_f32 v[136:137], v[136:137], v[152:153]
    v_pk_add_f32 v[138:139], v[138:139], v[154:155]
    v_pk_add_f32 v[136:137], v[136:137], v[168:169]
    v_pk_add_f32 v[138:139], v[138:139], v[170:171]
    v_pk_fma_f32 v[104:105], v[136:137], v[16:17], v[104:105] op_sel_hi:[1,0,1]
    v_pk_fma_f32 v[106:107], v[138:139], v[16:17], v[106:107] op_sel_hi:[1,0,1]
    s_waitcnt lgkmcnt(1)
    v_pk_add_f32 v[140:141], v[140:141], v[156:157]
    v_pk_add_f32 v[142:143], v[142:143], v[158:159]
    v_pk_add_f32 v[140:141], v[140:141], v[172:173]
    v_pk_add_f32 v[142:143], v[142:143], v[174:175]
    v_pk_fma_f32 v[108:109], v[140:141], v[16:17], v[108:109] op_sel_hi:[1,0,1]
    v_pk_fma_f32 v[110:111], v[142:143], v[16:17], v[110:111] op_sel_hi:[1,0,1]
    v_cvt_pk_bf16_f32 v116, v104, v105
    v_cvt_pk_bf16_f32 v117, v106, v107
    v_cvt_pk_bf16_f32 v118, v108, v109
    v_cvt_pk_bf16_f32 v119, v110, v111
    s_nop 0
    v_permlane32_swap_b32 v116, v118
    v_permlane32_swap_b32 v117, v119
    ds_write_b128 v28, v[116:119] offset:32
    ds_read_b128 v[128:131], v29 offset:0
    ds_read_b128 v[132:135], v29 offset:1280
    s_waitcnt lgkmcnt(1)
    buffer_store_dwordx4 v[128:131], v30, s[36:39], s86 offen
    s_waitcnt lgkmcnt(0)
    buffer_store_dwordx4 v[132:135], v30, s[36:39], s72 offen
L_END:
    s_endpgm
.section .rodata,"a"
.p2align 6
.amdhsa_kernel sequential_preLN__linear_kernel_hedgehog__glu_gated_bilinear__prompt_kernel
  .amdhsa_next_free_vgpr 512
  .amdhsa_next_free_sgpr 102
  .amdhsa_accum_offset 256
  .amdhsa_group_segment_fixed_size 0
  .amdhsa_kernarg_size 88
  .amdhsa_user_sgpr_count 2
  .amdhsa_user_sgpr_kernarg_segment_ptr 1
  .amdhsa_system_sgpr_workgroup_id_x 1
  .amdhsa_float_denorm_mode_32 3
.end_amdhsa_kernel
```
